```python
import torch

def _softmax(x, axis=-1):
    return torch.softmax(x, dim=axis)
def _gelu(x):
    return torch.nn.functional.gelu(x, approximate="tanh")
def _silu(x):
    return torch.nn.functional.silu(x)
def _sigmoid(x):
    return torch.sigmoid(x)
def _layernorm(x, axis=-1, eps=1e-5):
    m = x.mean(dim=axis, keepdim=True)
    v = x.var(dim=axis, keepdim=True, unbiased=False)
    return (x - m) / torch.sqrt(v + eps)
def _scatter_add(tgt, idx, src, axis=0):
    return tgt.clone().index_add_(axis, idx, src)
def _segment_sum(src, seg, n):
    out = torch.zeros((n,) + src.shape[1:], dtype=src.dtype)
    return out.index_add_(0, seg, src)
def _pad(x, pw):
    flat = tuple(v for pair in reversed(pw) for v in pair)
    return torch.nn.functional.pad(x, flat)

kernel_name = 'sequential_preLN__mha_block_cached__dense_activation_gelu__decode'

def setup_inputs():

    _w = (lambda a: (lambda t: t.to(torch.bfloat16) if t.is_floating_point() else t)(torch.as_tensor(a)))
    def _A_setup():
        B, Sq, D = 2, 1, 512
        H, Sk, Dh = 32, 4096, 128
        return {
            "x": _w((lambda *s: torch.randn(*s, dtype=torch.bfloat16) * 0.1)(B, Sq, D)),
            "k_cache": _w((lambda *s: torch.randn(*s, dtype=torch.bfloat16) * 1.6)(B, H, Sk, Dh)),
            "v_cache": _w((lambda *s: torch.randn(*s, dtype=torch.bfloat16) * 1.6)(B, H, Sk, Dh)),
            "wq": _w((lambda *s: torch.randn(*s, dtype=torch.bfloat16) * 1.6)(D, H * Dh) * (D ** -0.5)),
            "wo": _w((lambda *s: torch.randn(*s, dtype=torch.bfloat16) * 1.6)(H * Dh, D) * ((H * Dh) ** -0.5)),
        }
    _A_in = _A_setup()

    def _B_setup():
        B, S, D, F = 2, 1, 512, 1376
        return {
            "x": _w((lambda *s: torch.randn(*s, dtype=torch.bfloat16) * 0.1)(B, S, D)),
            "w1": _w((lambda *s: torch.randn(*s, dtype=torch.bfloat16) * 3.2)(D, F) * (D ** -0.5)),
            "b1": _w((lambda *s: torch.randn(*s, dtype=torch.bfloat16) * 3.2)(F) * 0.01),
            "w2": _w((lambda *s: torch.randn(*s, dtype=torch.bfloat16) * 3.2)(F, D) * (F ** -0.5)),
            "b2": _w((lambda *s: torch.randn(*s, dtype=torch.bfloat16) * 3.2)(D) * 0.01),
        }
    _B_in = _B_setup()

    return {
        "A_x": _A_in["x"],
        "A_k_cache": _A_in["k_cache"],
        "A_v_cache": _A_in["v_cache"],
        "A_wq": _A_in["wq"],
        "A_wo": _A_in["wo"],
        "B_x": _B_in["x"],
        "B_w1": _B_in["w1"],
        "B_b1": _B_in["b1"],
        "B_w2": _B_in["w2"],
        "B_b2": _B_in["b2"],
    }

def reference(A_x, A_k_cache, A_v_cache, A_wq, A_wo, B_x, B_w1, B_b1, B_w2, B_b2):
    def _A_ref(x, k_cache, v_cache, wq, wo):
        B, Sq, D = x.shape
        H, Dh = 32, 128
        q = (lambda x, *d: x.permute(*d))((x @ wq).reshape(B, Sq, H, Dh), 0, 2, 1, 3)
        scores = torch.einsum("bhqd,bhkd->bhqk", q, k_cache) * (Dh ** -0.5)
        p = _softmax(scores, axis=-1)
        o = torch.einsum("bhqk,bhkd->bhqd", p, v_cache)
        return (lambda x, *d: x.permute(*d))(o, 0, 2, 1, 3).reshape(B, Sq, H * Dh) @ wo

    def _B_ref(x, w1, b1, w2, b2):
        h = torch.einsum("bsd,df->bsf", x, w1) + b1
        h = _gelu(h)
        return torch.einsum("bsf,fd->bsd", h, w2) + b2

    x = A_x
    h = x + _A_ref(_layernorm(x, axis=-1), A_k_cache, A_v_cache, A_wq, A_wo)
    h2 = h + _B_ref(_layernorm(h, axis=-1), B_w1, B_b1, B_w2, B_b2)
    return h2
```

```asm
; @launch grid=(256,1,1) block=(1024,1,1) lds=157696
.amdgcn_target "amdgcn-amd-amdhsa--gfx950"
.text
.globl sequential_preLN__mha_block_cached__dense_activation_gelu__decode_kernel
.p2align 8
.type sequential_preLN__mha_block_cached__dense_activation_gelu__decode_kernel,@function
sequential_preLN__mha_block_cached__dense_activation_gelu__decode_kernel:
    s_cmp_ge_u32 s2, 256
    s_cbranch_scc1 L_end
    s_load_dwordx16 s[16:31], s[0:1], 0
    s_load_dwordx8 s[32:39], s[0:1], 64
    s_load_dwordx2 s[40:41], s[0:1], 96
    v_readfirstlane_b32 s3, v0
    v_and_b32 v0, 63, v0
    s_and_b32 s7, s2, 7
    s_lshr_b32 s8, s2, 3
    s_and_b32 s9, s8, 3
    s_lshl_b32 s4, s7, 2
    s_add_u32 s4, s4, s9
    s_mov_b32 s97, s4
    s_lshr_b32 s13, s8, 2
    s_lshr_b32 s5, s13, 2
    s_and_b32 s6, s13, 3
    s_lshr_b32 s3, s3, 6
    v_lshlrev_b32 v1, 4, v0
    v_lshrrev_b32 v3, 4, v0
    v_and_b32 v2, 15, v0
    v_lshlrev_b32 v2, 4, v2
    v_lshl_add_u32 v2, v3, 13, v2
    v_lshlrev_b32 v3, 1, v3
    v_bfe_u32 v8, v0, 3, 1
    v_lshl_add_u32 v3, v8, 10, v3
    s_lshl_b32 s96, s5, 5
    s_add_u32 s96, s96, s4
    s_lshl_b32 s92, s96, 20
    s_lshl_b32 s7, s6, 18
    s_add_u32 s92, s92, s7
    s_lshl_b32 s7, s3, 10
    s_add_u32 s92, s92, s7
    s_lshl_b32 s11, s13, 4
    s_add_u32 s11, s11, s3
    s_lshl_b32 s12, s11, 15
    s_lshl_b32 s7, s4, 8
    s_add_u32 s12, s12, s7
    s_lshl_b32 s11, s11, 3
    s_waitcnt lgkmcnt(0)
    s_mov_b32 s44, s18
    s_and_b32 s45, s19, 0xffff
    s_mov_b32 s46, 0x4000000
    s_mov_b32 s47, 0x00020000
    s_add_u32 s93, s92, 0
    buffer_load_dwordx4 v[64:67], v1, s[44:47], s93 offen nt
    s_mov_b32 s60, s16
    s_and_b32 s61, s17, 0xffff
    s_mov_b32 s62, 0x800
    s_mov_b32 s63, 0x00020000
    buffer_load_dwordx4 v[24:27], v1, s[60:63], 0 offen
    buffer_load_dwordx4 v[28:31], v1, s[60:63], 0 offen offset:1024
    buffer_load_ushort v3, v3, s[60:63], s11 offen
    s_mov_b32 s52, s22
    s_and_b32 s53, s23, 0xffff
    s_mov_b32 s54, 0x400000
    s_mov_b32 s55, 0x00020000
    buffer_load_dwordx4 v[60:63], v2, s[52:55], s12 offen nt
    s_add_u32 s93, s92, 16384
    buffer_load_dwordx4 v[68:71], v1, s[44:47], s93 offen nt
    s_mov_b32 s64, s40
    s_and_b32 s65, s41, 0xffff
    s_mov_b32 s66, 0x400000
    s_mov_b32 s67, 0x00020000
    s_mov_b32 s68, s38
    s_and_b32 s69, s39, 0xffff
    s_mov_b32 s70, 0x100
    s_mov_b32 s71, 0x00020000
    s_lshr_b32 s7, s2, 3
    s_or_b32 s7, s7, s3
    s_cmp_lg_u32 s7, 0
    s_cbranch_scc1 L_nononce
    s_memrealtime s[8:9]
    v_mov_b32 v12, 0
    v_mov_b32 v10, 0
    v_mov_b32 v11, 0
    s_waitcnt lgkmcnt(0)
    s_bitset1_b32 s9, 31
    v_mov_b32 v8, s8
    v_mov_b32 v9, s9
    s_mov_b64 exec, 1
    buffer_atomic_cmpswap_x2 v[8:11], v12, s[68:71], 0 offen sc1
    s_mov_b64 exec, -1
    s_nop 1
L_nononce:
    s_cmp_lg_u32 s3, 1
    s_cbranch_scc1 L_noclear
    v_mov_b32 v8, -1
    v_mov_b32 v9, -1
    v_mov_b32 v10, -1
    v_mov_b32 v11, -1
    s_lshl_b32 s7, s5, 7
    s_lshl_b32 s8, s4, 2
    s_add_u32 s7, s7, s8
    s_add_u32 s7, s7, s6
    s_lshl_b32 s7, s7, 11
    s_add_u32 s7, s7, 0x10000
    buffer_store_dwordx4 v[8:11], v1, s[64:67], s7 offen sc1
    buffer_store_dwordx4 v[8:11], v1, s[64:67], s7 offen offset:1024 sc1
    s_mov_b64 exec, 0xff
    ds_write_b128 v1, v[8:11] offset:21536
    s_cmp_lt_u32 s2, 224
    s_cbranch_scc1 L_noclrh
    s_lshl_b32 s7, s97, 7
    s_add_u32 s7, s7, 0x8000
    buffer_store_dwordx4 v[8:11], v1, s[64:67], s7 offen sc1
L_noclrh:
    s_mov_b64 exec, -1
    s_cmp_ge_u32 s2, 86
    s_cbranch_scc1 L_noclear
    s_lshl_b32 s7, s2, 12
    s_add_u32 s7, s7, 0x100000
    buffer_store_dwordx4 v[8:11], v1, s[64:67], s7 offen sc1
    buffer_store_dwordx4 v[8:11], v1, s[64:67], s7 offen offset:1024 sc1
    buffer_store_dwordx4 v[8:11], v1, s[64:67], s7 offen offset:2048 sc1
    buffer_store_dwordx4 v[8:11], v1, s[64:67], s7 offen offset:3072 sc1
L_noclear:
    v_mov_b32 v22, 0
    v_mov_b32 v23, 0
    s_mov_b32 s48, s20
    s_and_b32 s49, s21, 0xffff
    s_mov_b32 s50, 0x4000000
    s_mov_b32 s51, 0x00020000
    s_mov_b32 s56, s24
    s_and_b32 s57, s25, 0xffff
    s_mov_b32 s58, 0x400000
    s_mov_b32 s59, 0x00020000
    s_mov_b32 s72, s28
    s_and_b32 s73, s29, 0xffff
    s_mov_b32 s74, 0x158000
    s_mov_b32 s75, 0x00020000
    s_mov_b32 s76, s32
    s_and_b32 s77, s33, 0xffff
    s_mov_b32 s78, 0x158000
    s_mov_b32 s79, 0x00020000
    s_mov_b32 s80, s30
    s_and_b32 s81, s31, 0xffff
    s_mov_b32 s82, 0xac0
    s_mov_b32 s83, 0x00020000
    s_mov_b32 s84, s34
    s_and_b32 s85, s35, 0xffff
    s_mov_b32 s86, 0x400
    s_mov_b32 s87, 0x00020000
    s_mov_b32 s88, s36
    s_and_b32 s89, s37, 0xffff
    s_mov_b32 s90, 0x800
    s_mov_b32 s91, 0x00020000
    s_mov_b64 s[98:99], -1
    s_mov_b32 s42, 0x3fb8aa3b
    s_mov_b32 s43, 0x3db504f3
    s_lshl_b32 s94, s4, 17
    s_lshl_b32 s7, s3, 13
    s_add_u32 s94, s94, s7
    v_mov_b32 v16, 0
    v_mov_b32 v17, 0
    v_mov_b32 v18, 0
    v_mov_b32 v19, 0
    v_mov_b32 v20, 0
    v_mov_b32 v21, 0
    v_mov_b32 v52, 0
    v_mov_b32 v53, 0
    v_mov_b32 v54, 0
    v_and_b32 v12, 1, v0
    v_lshlrev_b32 v12, 4, v12
    v_mov_b32 v13, 0xffff
    v_lshlrev_b32 v13, v12, v13
    v_bfe_u32 v12, v0, 1, 2
    v_cmp_eq_u32 vcc, 0, v12
    s_nop 1
    v_cndmask_b32 v4, 0, v13, vcc
    v_cmp_eq_u32 vcc, 1, v12
    s_nop 1
    v_cndmask_b32 v5, 0, v13, vcc
    v_cmp_eq_u32 vcc, 2, v12
    s_nop 1
    v_cndmask_b32 v6, 0, v13, vcc
    v_cmp_eq_u32 vcc, 3, v12
    s_nop 1
    v_cndmask_b32 v7, 0, v13, vcc
    s_waitcnt vmcnt(4)
    v_lshlrev_b32 v32, 16, v24
    v_and_b32 v33, 0xffff0000, v24
    v_lshlrev_b32 v34, 16, v25
    v_and_b32 v35, 0xffff0000, v25
    v_lshlrev_b32 v36, 16, v26
    v_and_b32 v37, 0xffff0000, v26
    v_lshlrev_b32 v38, 16, v27
    v_and_b32 v39, 0xffff0000, v27
    s_waitcnt vmcnt(3)
    v_lshlrev_b32 v40, 16, v28
    v_and_b32 v41, 0xffff0000, v28
    v_lshlrev_b32 v42, 16, v29
    v_and_b32 v43, 0xffff0000, v29
    v_lshlrev_b32 v44, 16, v30
    v_and_b32 v45, 0xffff0000, v30
    v_lshlrev_b32 v46, 16, v31
    v_and_b32 v47, 0xffff0000, v31
    v_add_f32 v8, v32, v33
    v_add_f32 v10, v34, v35
    v_add_f32 v12, v36, v37
    v_add_f32 v14, v38, v39
    v_add_f32 v9, v40, v41
    v_add_f32 v11, v42, v43
    v_add_f32 v13, v44, v45
    v_add_f32 v15, v46, v47
    v_add_f32 v8, v8, v10
    v_add_f32 v12, v12, v14
    v_add_f32 v9, v9, v11
    v_add_f32 v13, v13, v15
    v_add_f32 v8, v8, v12
    v_add_f32 v9, v9, v13
    s_nop 0
    v_add_f32_dpp v8, v8, v8 row_ror:8 row_mask:0xf bank_mask:0xf
    v_add_f32_dpp v9, v9, v9 row_ror:8 row_mask:0xf bank_mask:0xf
    s_nop 0
    v_add_f32_dpp v8, v8, v8 row_ror:4 row_mask:0xf bank_mask:0xf
    v_add_f32_dpp v9, v9, v9 row_ror:4 row_mask:0xf bank_mask:0xf
    s_nop 0
    v_add_f32_dpp v8, v8, v8 row_ror:2 row_mask:0xf bank_mask:0xf
    v_add_f32_dpp v9, v9, v9 row_ror:2 row_mask:0xf bank_mask:0xf
    s_nop 0
    v_add_f32_dpp v8, v8, v8 row_ror:1 row_mask:0xf bank_mask:0xf
    v_add_f32_dpp v9, v9, v9 row_ror:1 row_mask:0xf bank_mask:0xf
    s_nop 0
    v_add_f32_dpp v8, v8, v8 row_bcast:15 row_mask:0xa bank_mask:0xf
    v_add_f32_dpp v9, v9, v9 row_bcast:15 row_mask:0xa bank_mask:0xf
    s_nop 0
    v_add_f32_dpp v8, v8, v8 row_bcast:31 row_mask:0xc bank_mask:0xf
    v_add_f32_dpp v9, v9, v9 row_bcast:31 row_mask:0xc bank_mask:0xf
    v_readlane_b32 s7, v8, 63
    v_readlane_b32 s8, v9, 63
    s_add_u32 s93, s92, 32768
    buffer_load_dwordx4 v[72:75], v1, s[44:47], s93 offen nt
    s_cmp_lg_u32 s3, 1
    s_cbranch_scc1 L_nn1
    buffer_load_dwordx2 v[22:23], v20, s[68:71], 0 offen sc1
L_nn1:
    v_mov_b32 v12, 0x3b000000
    v_mul_f32 v16, s7, v12
    v_mul_f32 v17, s8, v12
    v_sub_f32 v32, v32, v16
    v_sub_f32 v33, v33, v16
    v_sub_f32 v34, v34, v16
    v_sub_f32 v35, v35, v16
    v_sub_f32 v36, v36, v16
    v_sub_f32 v37, v37, v16
    v_sub_f32 v38, v38, v16
    v_sub_f32 v39, v39, v16
    v_sub_f32 v40, v40, v17
    v_sub_f32 v41, v41, v17
    v_sub_f32 v42, v42, v17
    v_sub_f32 v43, v43, v17
    v_sub_f32 v44, v44, v17
    v_sub_f32 v45, v45, v17
    v_sub_f32 v46, v46, v17
    v_sub_f32 v47, v47, v17
    v_mul_f32 v8, v32, v32
    v_mul_f32 v9, v40, v40
    v_fmac_f32 v8, v33, v33
    v_fmac_f32 v9, v41, v41
    v_fmac_f32 v8, v34, v34
    v_fmac_f32 v9, v42, v42
    v_fmac_f32 v8, v35, v35
    v_fmac_f32 v9, v43, v43
    v_fmac_f32 v8, v36, v36
    v_fmac_f32 v9, v44, v44
    v_fmac_f32 v8, v37, v37
    v_fmac_f32 v9, v45, v45
    v_fmac_f32 v8, v38, v38
    v_fmac_f32 v9, v46, v46
    v_fmac_f32 v8, v39, v39
    v_fmac_f32 v9, v47, v47
    s_nop 0
    v_add_f32_dpp v8, v8, v8 row_ror:8 row_mask:0xf bank_mask:0xf
    v_add_f32_dpp v9, v9, v9 row_ror:8 row_mask:0xf bank_mask:0xf
    s_nop 0
    v_add_f32_dpp v8, v8, v8 row_ror:4 row_mask:0xf bank_mask:0xf
    v_add_f32_dpp v9, v9, v9 row_ror:4 row_mask:0xf bank_mask:0xf
    s_nop 0
    v_add_f32_dpp v8, v8, v8 row_ror:2 row_mask:0xf bank_mask:0xf
    v_add_f32_dpp v9, v9, v9 row_ror:2 row_mask:0xf bank_mask:0xf
    s_nop 0
    v_add_f32_dpp v8, v8, v8 row_ror:1 row_mask:0xf bank_mask:0xf
    v_add_f32_dpp v9, v9, v9 row_ror:1 row_mask:0xf bank_mask:0xf
    s_nop 0
    v_add_f32_dpp v8, v8, v8 row_bcast:15 row_mask:0xa bank_mask:0xf
    v_add_f32_dpp v9, v9, v9 row_bcast:15 row_mask:0xa bank_mask:0xf
    s_nop 0
    v_add_f32_dpp v8, v8, v8 row_bcast:31 row_mask:0xc bank_mask:0xf
    v_add_f32_dpp v9, v9, v9 row_bcast:31 row_mask:0xc bank_mask:0xf
    v_readlane_b32 s7, v8, 63
    v_readlane_b32 s8, v9, 63
    s_waitcnt vmcnt(1)
    s_add_u32 s93, s92, 49152
    buffer_load_dwordx4 v[76:79], v1, s[44:47], s93 offen nt
    v_mul_f32 v18, s7, v12
    v_mul_f32 v19, s8, v12
    s_mov_b32 s8, 0xff00ff00
    s_mov_b32 s9, 0xff00ff00
    v_cndmask_b32 v13, v16, v17, s[8:9]
    v_cndmask_b32 v14, v18, v19, s[8:9]
    v_cvt_pk_bf16_f32 v15, v13, v14
    v_lshlrev_b32 v13, 16, v15
    v_and_b32 v14, 0xffff0000, v15
    v_add_f32 v14, 0x3727c5ac, v14
    v_cvt_pk_bf16_f32 v14, v14, v14
    v_and_b32 v14, 0xffff0000, v14
    v_sqrt_f32 v14, v14
    s_nop 0
    v_cvt_pk_bf16_f32 v14, v14, v14
    v_and_b32 v14, 0xffff0000, v14
    v_rcp_f32 v14, v14
    v_lshlrev_b32 v3, 16, v3
    v_sub_f32 v3, v3, v13
    v_cvt_pk_bf16_f32 v3, v3, v3
    v_and_b32 v3, 0xffff0000, v3
    v_mul_f32 v3, v3, v14
    v_cvt_pk_bf16_f32 v16, v3, v3
    v_and_b32 v8, v16, v4
    v_and_b32 v9, v16, v5
    v_and_b32 v10, v16, v6
    v_and_b32 v11, v16, v7
    s_nop 1
    v_mfma_f32_16x16x32_bf16 v[12:15], v[60:63], v[8:11], 0
    v_lshrrev_b32 v16, 4, v0
    v_and_b32 v17, 7, v0
    v_lshl_add_u32 v16, v16, 5, v17
    v_bfe_u32 v17, v0, 3, 1
    v_lshl_add_u32 v16, v17, 7, v16
    v_mul_u32_u24 v16, 80, v16
    s_lshl_b32 s7, s3, 2
    v_add_u32 v16, s7, v16
    ds_write_b32 v16, v12 offset:0
    ds_write_b32 v16, v13 offset:640
    ds_write_b32 v16, v14 offset:1280
    ds_write_b32 v16, v15 offset:1920
    s_add_u32 s93, s94, 0
    s_mul_i32 s101, s3, 8448
    s_add_u32 m0, s101, 22528
    s_nop 0
    buffer_load_dwordx4 v1, s[56:59], s93 offen nt lds
    s_waitcnt vmcnt(2)
    s_add_u32 s93, s92, 65536
    buffer_load_dwordx4 v[80:83], v1, s[44:47], s93 offen nt
    s_waitcnt vmcnt(2)
    s_add_u32 s93, s92, 81920
    buffer_load_dwordx4 v[84:87], v1, s[44:47], s93 offen nt
    s_add_u32 s93, s92, 98304
    buffer_load_dwordx4 v[88:91], v1, s[44:47], s93 offen nt
    s_cmp_lg_u32 s3, 1
    s_cbranch_scc1 L_clrok
    v_cmp_ne_u32 vcc, 0, v23
    s_cmp_lg_u64 vcc, 0
    s_cbranch_scc1 L_nonceok
    s_memrealtime s[8:9]
    v_mov_b32 v20, 0
    v_mov_b32 v10, 0
    v_mov_b32 v11, 0
    s_waitcnt lgkmcnt(0)
    s_bitset1_b32 s9, 31
    v_mov_b32 v8, s8
    v_mov_b32 v9, s9
    s_mov_b64 exec, 1
    buffer_atomic_cmpswap_x2 v[8:11], v20, s[68:71], 0 offen sc0 sc1
    s_waitcnt vmcnt(0)
    v_cmp_eq_u32 vcc, 0, v9
    v_mov_b32 v22, s8
    v_mov_b32 v23, s9
    v_cndmask_b32 v22, v8, v22, vcc
    v_cndmask_b32 v23, v9, v23, vcc
    s_mov_b64 exec, -1
L_nonceok:
    v_mov_b32 v20, 0
    s_mov_b64 exec, 1
    ds_write_b64 v20, v[22:23] offset:21520
    s_mov_b64 exec, -1
L_clrok:
    s_waitcnt lgkmcnt(0)
    s_barrier
    v_mov_b32 v20, 0
    ds_read_b64 v[22:23], v20 offset:21520
    s_waitcnt lgkmcnt(0)
    v_readfirstlane_b32 s40, v22
    v_readfirstlane_b32 s41, v23
    s_cmp_lg_u32 s3, 2
    s_cbranch_scc1 L_nopub
    v_mul_u32_u24 v16, 320, v0
    ds_read_b128 v[32:35], v16 offset:0
    ds_read_b128 v[36:39], v16 offset:16
    ds_read_b128 v[40:43], v16 offset:32
    ds_read_b128 v[44:47], v16 offset:48
    ds_read_b128 v[48:51], v16 offset:80
    ds_read_b128 v[52:55], v16 offset:96
    ds_read_b128 v[56:59], v16 offset:112
    ds_read_b128 v[60:63], v16 offset:128
    s_waitcnt lgkmcnt(7)
    v_add_f32 v32, v32, v33
    v_add_f32 v34, v34, v35
    s_waitcnt lgkmcnt(6)
    v_add_f32 v36, v36, v37
    v_add_f32 v38, v38, v39
    s_waitcnt lgkmcnt(5)
    v_add_f32 v40, v40, v41
    v_add_f32 v42, v42, v43
    s_waitcnt lgkmcnt(4)
    v_add_f32 v44, v44, v45
    v_add_f32 v46, v46, v47
    v_add_f32 v32, v32, v34
    v_add_f32 v36, v36, v38
    v_add_f32 v40, v40, v42
    v_add_f32 v44, v44, v46
    v_add_f32 v32, v32, v36
    v_add_f32 v40, v40, v44
    v_add_f32 v32, v32, v40
    v_mov_b32 v8, v32
    s_waitcnt lgkmcnt(3)
    v_add_f32 v48, v48, v49
    v_add_f32 v50, v50, v51
    s_waitcnt lgkmcnt(2)
    v_add_f32 v52, v52, v53
    v_add_f32 v54, v54, v55
    s_waitcnt lgkmcnt(1)
    v_add_f32 v56, v56, v57
    v_add_f32 v58, v58, v59
    s_waitcnt lgkmcnt(0)
    v_add_f32 v60, v60, v61
    v_add_f32 v62, v62, v63
    v_add_f32 v48, v48, v50
    v_add_f32 v52, v52, v54
    v_add_f32 v56, v56, v58
    v_add_f32 v60, v60, v62
    v_add_f32 v48, v48, v52
    v_add_f32 v56, v56, v60
    v_add_f32 v48, v48, v56
    v_mov_b32 v9, v48
    v_mov_b32 v10, v22
    v_mov_b32 v11, v23
    ds_read_b128 v[32:35], v16 offset:160
    ds_read_b128 v[36:39], v16 offset:176
    ds_read_b128 v[40:43], v16 offset:192
    ds_read_b128 v[44:47], v16 offset:208
    ds_read_b128 v[48:51], v16 offset:240
    ds_read_b128 v[52:55], v16 offset:256
    ds_read_b128 v[56:59], v16 offset:272
    ds_read_b128 v[60:63], v16 offset:288
    s_waitcnt lgkmcnt(7)
    v_add_f32 v32, v32, v33
    v_add_f32 v34, v34, v35
    s_waitcnt lgkmcnt(6)
    v_add_f32 v36, v36, v37
    v_add_f32 v38, v38, v39
    s_waitcnt lgkmcnt(5)
    v_add_f32 v40, v40, v41
    v_add_f32 v42, v42, v43
    s_waitcnt lgkmcnt(4)
    v_add_f32 v44, v44, v45
    v_add_f32 v46, v46, v47
    v_add_f32 v32, v32, v34
    v_add_f32 v36, v36, v38
    v_add_f32 v40, v40, v42
    v_add_f32 v44, v44, v46
    v_add_f32 v32, v32, v36
    v_add_f32 v40, v40, v44
    v_add_f32 v32, v32, v40
    v_mov_b32 v12, v32
    s_waitcnt lgkmcnt(3)
    v_add_f32 v48, v48, v49
    v_add_f32 v50, v50, v51
    s_waitcnt lgkmcnt(2)
    v_add_f32 v52, v52, v53
    v_add_f32 v54, v54, v55
    s_waitcnt lgkmcnt(1)
    v_add_f32 v56, v56, v57
    v_add_f32 v58, v58, v59
    s_waitcnt lgkmcnt(0)
    v_add_f32 v60, v60, v61
    v_add_f32 v62, v62, v63
    v_add_f32 v48, v48, v50
    v_add_f32 v52, v52, v54
    v_add_f32 v56, v56, v58
    v_add_f32 v60, v60, v62
    v_add_f32 v48, v48, v52
    v_add_f32 v56, v56, v60
    v_add_f32 v48, v48, v56
    v_mov_b32 v13, v48
    v_mov_b32 v14, v22
    v_mov_b32 v15, v23
    s_lshl_b32 s7, s4, 14
    s_lshl_b32 s8, s5, 13
    s_add_u32 s7, s7, s8
    s_lshl_b32 s8, s6, 11
    s_add_u32 s7, s7, s8
    s_add_u32 s7, s7, 0x180000
    buffer_store_dwordx4 v[8:11], v1, s[64:67], s7 offen sc1
    buffer_store_dwordx4 v[12:15], v1, s[64:67], s7 offen offset:1024 sc1
L_nopub:
    s_add_u32 s93, s94, 1024
    s_mul_i32 s101, s3, 8448
    s_add_u32 m0, s101, 23584
    s_nop 0
    buffer_load_dwordx4 v1, s[56:59], s93 offen nt lds
    s_mov_b64 s[98:99], 0
    s_mov_b64 exec, 0
    s_cmp_eq_u32 s3, 4
    s_cbranch_scc1 L_segA
    s_cmp_eq_u32 s3, 5
    s_cbranch_scc1 L_segB
    s_cmp_eq_u32 s3, 6
    s_cbranch_scc1 L_segC
    s_cmp_eq_u32 s3, 7
    s_cbranch_scc1 L_segD
    s_cmp_eq_u32 s3, 8
    s_cbranch_scc1 L_segE
    s_cmp_eq_u32 s3, 9
    s_cbranch_scc1 L_segF
    s_cmp_eq_u32 s3, 10
    s_cbranch_scc1 L_segH
    s_cmp_eq_u32 s3, 11
    s_cbranch_scc1 L_segI
    s_cmp_eq_u32 s3, 12
    s_cbranch_scc1 L_segJ
    s_cmp_eq_u32 s3, 13
    s_cbranch_scc1 L_segK0
    s_cmp_eq_u32 s3, 14
    s_cbranch_scc1 L_segK2
    s_cmp_eq_u32 s3, 15
    s_cbranch_scc1 L_segSM
    s_cmp_eq_u32 s3, 0
    s_cbranch_scc1 L_segV0
    s_cmp_eq_u32 s3, 1
    s_cbranch_scc1 L_segV9
    s_cmp_eq_u32 s3, 2
    s_cbranch_scc1 L_segV12
L_dryret:
    s_mov_b64 s[98:99], -1
    s_mov_b64 exec, -1
    s_waitcnt lgkmcnt(0)
    s_nop 9
    s_waitcnt vmcnt(2)
    s_add_u32 s93, s92, 114688
    buffer_load_dwordx4 v[92:95], v1, s[44:47], s93 offen nt
    s_waitcnt vmcnt(2)
    s_add_u32 s93, s92, 131072
    buffer_load_dwordx4 v[96:99], v1, s[44:47], s93 offen nt
    s_waitcnt vmcnt(1)
    s_add_u32 s93, s92, 147456
    buffer_load_dwordx4 v[100:103], v1, s[44:47], s93 offen nt
    s_add_u32 s93, s94, 2048
    s_mul_i32 s101, s3, 8448
    s_add_u32 m0, s101, 24640
    s_nop 0
    buffer_load_dwordx4 v1, s[56:59], s93 offen nt lds
    s_waitcnt vmcnt(2)
    s_add_u32 s93, s92, 163840
    buffer_load_dwordx4 v[104:107], v1, s[44:47], s93 offen nt
    s_waitcnt vmcnt(2)
    s_add_u32 s93, s92, 180224
    buffer_load_dwordx4 v[108:111], v1, s[44:47], s93 offen nt
    s_waitcnt vmcnt(1)
    s_add_u32 s93, s92, 196608
    buffer_load_dwordx4 v[112:115], v1, s[44:47], s93 offen nt
    s_cmp_lg_u32 s3, 3
    s_cbranch_scc1 L_g1
    v_lshrrev_b32 v12, 5, v0
    v_and_b32 v13, 31, v0
    v_lshlrev_b32 v13, 4, v13
    v_lshl_add_u32 v12, v12, 11, v13
    s_lshl_b32 s7, s4, 14
    s_lshl_b32 s8, s5, 9
    s_add_u32 s7, s7, s8
    s_add_u32 s7, s7, 0x180000
    buffer_load_dwordx4 v[32:35], v12, s[64:67], s7 offen sc1
    buffer_load_dwordx4 v[36:39], v12, s[64:67], s7 offen offset:1024 sc1
    s_add_u32 s7, s7, 4096
    buffer_load_dwordx4 v[40:43], v12, s[64:67], s7 offen sc1
    buffer_load_dwordx4 v[44:47], v12, s[64:67], s7 offen offset:1024 sc1
    s_add_u32 s7, s7, 4096
    buffer_load_dwordx4 v[48:51], v12, s[64:67], s7 offen sc1
    buffer_load_dwordx4 v[52:55], v12, s[64:67], s7 offen offset:1024 sc1
    s_add_u32 s7, s7, 4096
    buffer_load_dwordx4 v[56:59], v12, s[64:67], s7 offen sc1
    buffer_load_dwordx4 v[60:63], v12, s[64:67], s7 offen offset:1024 sc1
L_g1:
    s_add_u32 s93, s94, 3072
    s_mul_i32 s101, s3, 8448
    s_add_u32 m0, s101, 25696
    s_nop 0
    buffer_load_dwordx4 v1, s[56:59], s93 offen nt lds
    s_waitcnt vmcnt(2)
    s_add_u32 s93, s92, 212992
    buffer_load_dwordx4 v[116:119], v1, s[44:47], s93 offen nt
    s_waitcnt vmcnt(2)
    s_add_u32 s93, s92, 229376
    buffer_load_dwordx4 v[120:123], v1, s[44:47], s93 offen nt
    s_cmp_lg_u32 s3, 3
    s_cbranch_scc1 L_nogather
    v_xor_b32 v16, s40, v34
    v_xor_b32 v24, s41, v35
    v_xor_b32 v17, s40, v38
    v_xor_b32 v25, s41, v39
    v_xor_b32 v18, s40, v42
    v_xor_b32 v26, s41, v43
    v_xor_b32 v19, s40, v46
    v_xor_b32 v27, s41, v47
    v_xor_b32 v20, s40, v50
    v_xor_b32 v28, s41, v51
    v_xor_b32 v21, s40, v54
    v_xor_b32 v29, s41, v55
    v_xor_b32 v22, s40, v58
    v_xor_b32 v30, s41, v59
    v_xor_b32 v23, s40, v62
    v_xor_b32 v31, s41, v63
    v_or3_b32 v16, v16, v17, v18
    v_or3_b32 v20, v20, v21, v22
    v_or3_b32 v24, v24, v25, v26
    v_or3_b32 v28, v28, v29, v30
    v_or_b32 v16, v16, v19
    v_or_b32 v20, v20, v23
    v_or_b32 v24, v24, v27
    v_or_b32 v28, v28, v31
    v_or3_b32 v16, v16, v20, v24
    v_or_b32 v16, v16, v28
    v_cmp_ne_u32 vcc, 0, v16
    s_cmp_eq_u64 vcc, 0
    s_cbranch_scc1 L_qok
    s_mov_b32 s29, 0
L_qspin:
    s_lshl_b32 s7, s4, 14
    s_lshl_b32 s8, s5, 9
    s_add_u32 s7, s7, s8
    s_add_u32 s7, s7, 0x180000
    buffer_load_dwordx4 v[32:35], v12, s[64:67], s7 offen sc1
    buffer_load_dwordx4 v[36:39], v12, s[64:67], s7 offen offset:1024 sc1
    s_add_u32 s7, s7, 4096
    buffer_load_dwordx4 v[40:43], v12, s[64:67], s7 offen sc1
    buffer_load_dwordx4 v[44:47], v12, s[64:67], s7 offen offset:1024 sc1
    s_add_u32 s7, s7, 4096
    buffer_load_dwordx4 v[48:51], v12, s[64:67], s7 offen sc1
    buffer_load_dwordx4 v[52:55], v12, s[64:67], s7 offen offset:1024 sc1
    s_add_u32 s7, s7, 4096
    buffer_load_dwordx4 v[56:59], v12, s[64:67], s7 offen sc1
    buffer_load_dwordx4 v[60:63], v12, s[64:67], s7 offen offset:1024 sc1
    s_waitcnt vmcnt(0)
    v_xor_b32 v16, s40, v34
    v_xor_b32 v24, s41, v35
    v_xor_b32 v17, s40, v38
    v_xor_b32 v25, s41, v39
    v_xor_b32 v18, s40, v42
    v_xor_b32 v26, s41, v43
    v_xor_b32 v19, s40, v46
    v_xor_b32 v27, s41, v47
    v_xor_b32 v20, s40, v50
    v_xor_b32 v28, s41, v51
    v_xor_b32 v21, s40, v54
    v_xor_b32 v29, s41, v55
    v_xor_b32 v22, s40, v58
    v_xor_b32 v30, s41, v59
    v_xor_b32 v23, s40, v62
    v_xor_b32 v31, s41, v63
    v_or3_b32 v16, v16, v17, v18
    v_or3_b32 v20, v20, v21, v22
    v_or3_b32 v24, v24, v25, v26
    v_or3_b32 v28, v28, v29, v30
    v_or_b32 v16, v16, v19
    v_or_b32 v20, v20, v23
    v_or_b32 v24, v24, v27
    v_or_b32 v28, v28, v31
    v_or3_b32 v16, v16, v20, v24
    v_or_b32 v16, v16, v28
    v_cmp_ne_u32 vcc, 0, v16
    s_cmp_eq_u64 vcc, 0
    s_cbranch_scc1 L_qok
    s_add_u32 s29, s29, 1
    s_cmp_lt_u32 s29, 200000
    s_sleep 2
    s_cbranch_scc1 L_qspin
L_qok:
    v_add_f32 v16, v32, v40
    v_add_f32 v20, v48, v56
    v_add_f32 v17, v33, v41
    v_add_f32 v21, v49, v57
    v_add_f32 v18, v36, v44
    v_add_f32 v22, v52, v60
    v_add_f32 v19, v37, v45
    v_add_f32 v23, v53, v61
    v_add_f32 v16, v16, v20
    v_add_f32 v17, v17, v21
    v_add_f32 v18, v18, v22
    v_add_f32 v19, v19, v23
    v_mov_b32 v20, v16
    v_mov_b32 v21, v17
    v_mov_b32 v22, v18
    v_mov_b32 v23, v19
    v_permlane32_swap_b32 v16, v20
    v_permlane32_swap_b32 v17, v21
    v_permlane32_swap_b32 v18, v22
    v_permlane32_swap_b32 v19, v23
    v_add_f32 v16, v16, v20
    v_add_f32 v17, v17, v21
    v_add_f32 v18, v18, v22
    v_add_f32 v19, v19, v23
    v_cvt_pk_bf16_f32 v14, v16, v17
    v_cvt_pk_bf16_f32 v15, v18, v19
    v_lshrrev_b32 v13, 1, v13
    ds_write_b64 v13, v[14:15] offset:20480
L_nogather:
    s_waitcnt vmcnt(1)
    s_add_u32 s93, s92, 245760
    buffer_load_dwordx4 v[124:127], v1, s[44:47], s93 offen nt
    s_add_u32 s93, s94, 4096
    s_mul_i32 s101, s3, 8448
    s_add_u32 m0, s101, 26752
    s_nop 0
    buffer_load_dwordx4 v1, s[56:59], s93 offen nt lds
    s_waitcnt lgkmcnt(0)
    s_barrier
    v_and_b32 v12, 15, v0
    v_lshlrev_b32 v12, 4, v12
    ds_read_b128 v[8:11], v12 offset:20480
L_segK0:
    s_waitcnt lgkmcnt(0)
    v_dot2_f32_bf16 v16, v64, v8, 0
    v_dot2_f32_bf16 v17, v68, v8, 0
    v_dot2_f32_bf16 v18, v72, v8, 0
    v_dot2_f32_bf16 v19, v76, v8, 0
    v_dot2_f32_bf16 v16, v65, v9, v16
    v_dot2_f32_bf16 v17, v69, v9, v17
    v_dot2_f32_bf16 v18, v73, v9, v18
    v_dot2_f32_bf16 v19, v77, v9, v19
    v_dot2_f32_bf16 v16, v66, v10, v16
    v_dot2_f32_bf16 v17, v70, v10, v17
    v_dot2_f32_bf16 v18, v74, v10, v18
    v_dot2_f32_bf16 v19, v78, v10, v19
    v_dot2_f32_bf16 v16, v67, v11, v16
    v_dot2_f32_bf16 v17, v71, v11, v17
    v_dot2_f32_bf16 v18, v75, v11, v18
    v_dot2_f32_bf16 v19, v79, v11, v19
    s_cbranch_execz Lw_1
    s_waitcnt vmcnt(2)
Lw_1:
    s_add_u32 s93, s92, 0
    buffer_load_dwordx4 v[32:35], v1, s[48:51], s93 offen nt
    v_add_f32_dpp v16, v16, v16 row_ror:8 row_mask:0xf bank_mask:0xf
    v_add_f32_dpp v17, v17, v17 row_ror:8 row_mask:0xf bank_mask:0xf
    v_add_f32_dpp v18, v18, v18 row_ror:8 row_mask:0xf bank_mask:0xf
    v_add_f32_dpp v19, v19, v19 row_ror:8 row_mask:0xf bank_mask:0xf
    v_add_f32_dpp v16, v16, v16 row_ror:4 row_mask:0xf bank_mask:0xf
    v_add_f32_dpp v17, v17, v17 row_ror:4 row_mask:0xf bank_mask:0xf
    v_add_f32_dpp v18, v18, v18 row_ror:4 row_mask:0xf bank_mask:0xf
    v_add_f32_dpp v19, v19, v19 row_ror:4 row_mask:0xf bank_mask:0xf
    v_add_f32_dpp v16, v16, v16 row_ror:2 row_mask:0xf bank_mask:0xf
    v_add_f32_dpp v17, v17, v17 row_ror:2 row_mask:0xf bank_mask:0xf
    v_add_f32_dpp v18, v18, v18 row_ror:2 row_mask:0xf bank_mask:0xf
    v_add_f32_dpp v19, v19, v19 row_ror:2 row_mask:0xf bank_mask:0xf
    v_add_f32_dpp v16, v16, v16 row_ror:1 row_mask:0xf bank_mask:0xf
    v_add_f32_dpp v17, v17, v17 row_ror:1 row_mask:0xf bank_mask:0xf
    v_add_f32_dpp v18, v18, v18 row_ror:1 row_mask:0xf bank_mask:0xf
    v_add_f32_dpp v19, v19, v19 row_ror:1 row_mask:0xf bank_mask:0xf
    v_cvt_pk_bf16_f32 v12, v16, v17
    v_lshlrev_b32 v16, 16, v12
    v_and_b32 v17, 0xffff0000, v12
    v_cvt_pk_bf16_f32 v14, v18, v19
    v_lshlrev_b32 v18, 16, v14
    v_and_b32 v19, 0xffff0000, v14
    v_mul_f32 v16, s43, v16
    v_mul_f32 v17, s43, v17
    v_mul_f32 v18, s43, v18
    v_mul_f32 v19, s43, v19
    v_cvt_pk_bf16_f32 v12, v16, v17
    v_lshlrev_b32 v16, 16, v12
    v_and_b32 v17, 0xffff0000, v12
    v_cvt_pk_bf16_f32 v14, v18, v19
    v_lshlrev_b32 v18, 16, v14
    v_and_b32 v19, 0xffff0000, v14
    v_dot2_f32_bf16 v20, v80, v8, 0
    v_dot2_f32_bf16 v21, v84, v8, 0
    v_dot2_f32_bf16 v22, v88, v8, 0
    v_dot2_f32_bf16 v23, v92, v8, 0
    v_dot2_f32_bf16 v20, v81, v9, v20
    v_dot2_f32_bf16 v21, v85, v9, v21
    v_dot2_f32_bf16 v22, v89, v9, v22
    v_dot2_f32_bf16 v23, v93, v9, v23
    v_dot2_f32_bf16 v20, v82, v10, v20
    v_dot2_f32_bf16 v21, v86, v10, v21
    v_dot2_f32_bf16 v22, v90, v10, v22
    v_dot2_f32_bf16 v23, v94, v10, v23
    v_dot2_f32_bf16 v20, v83, v11, v20
    v_dot2_f32_bf16 v21, v87, v11, v21
    v_dot2_f32_bf16 v22, v91, v11, v22
    v_dot2_f32_bf16 v23, v95, v11, v23
    s_cbranch_execz Lw_2
    s_waitcnt vmcnt(2)
Lw_2:
    s_add_u32 s93, s92, 16384
    buffer_load_dwordx4 v[36:39], v1, s[48:51], s93 offen nt
    v_add_f32_dpp v20, v20, v20 row_ror:8 row_mask:0xf bank_mask:0xf
    v_add_f32_dpp v21, v21, v21 row_ror:8 row_mask:0xf bank_mask:0xf
    v_add_f32_dpp v22, v22, v22 row_ror:8 row_mask:0xf bank_mask:0xf
    v_add_f32_dpp v23, v23, v23 row_ror:8 row_mask:0xf bank_mask:0xf
    v_add_f32_dpp v20, v20, v20 row_ror:4 row_mask:0xf bank_mask:0xf
    v_add_f32_dpp v21, v21, v21 row_ror:4 row_mask:0xf bank_mask:0xf
    v_add_f32_dpp v22, v22, v22 row_ror:4 row_mask:0xf bank_mask:0xf
    v_add_f32_dpp v23, v23, v23 row_ror:4 row_mask:0xf bank_mask:0xf
    v_add_f32_dpp v20, v20, v20 row_ror:2 row_mask:0xf bank_mask:0xf
    v_add_f32_dpp v21, v21, v21 row_ror:2 row_mask:0xf bank_mask:0xf
    v_add_f32_dpp v22, v22, v22 row_ror:2 row_mask:0xf bank_mask:0xf
    v_add_f32_dpp v23, v23, v23 row_ror:2 row_mask:0xf bank_mask:0xf
    v_add_f32_dpp v20, v20, v20 row_ror:1 row_mask:0xf bank_mask:0xf
    v_add_f32_dpp v21, v21, v21 row_ror:1 row_mask:0xf bank_mask:0xf
    v_add_f32_dpp v22, v22, v22 row_ror:1 row_mask:0xf bank_mask:0xf
    v_add_f32_dpp v23, v23, v23 row_ror:1 row_mask:0xf bank_mask:0xf
    v_cvt_pk_bf16_f32 v12, v20, v21
    v_lshlrev_b32 v20, 16, v12
    v_and_b32 v21, 0xffff0000, v12
    v_cvt_pk_bf16_f32 v14, v22, v23
    v_lshlrev_b32 v22, 16, v14
    v_and_b32 v23, 0xffff0000, v14
    v_mul_f32 v20, s43, v20
    v_mul_f32 v21, s43, v21
    v_mul_f32 v22, s43, v22
    v_mul_f32 v23, s43, v23
    v_cvt_pk_bf16_f32 v12, v20, v21
    v_lshlrev_b32 v20, 16, v12
    v_and_b32 v21, 0xffff0000, v12
    v_cvt_pk_bf16_f32 v14, v22, v23
    v_lshlrev_b32 v22, 16, v14
    v_and_b32 v23, 0xffff0000, v14
    s_cbranch_execz L_dryret
L_segK2:
    v_dot2_f32_bf16 v24, v96, v8, 0
    v_dot2_f32_bf16 v25, v100, v8, 0
    v_dot2_f32_bf16 v26, v104, v8, 0
    v_dot2_f32_bf16 v27, v108, v8, 0
    v_dot2_f32_bf16 v24, v97, v9, v24
    v_dot2_f32_bf16 v25, v101, v9, v25
    v_dot2_f32_bf16 v26, v105, v9, v26
    v_dot2_f32_bf16 v27, v109, v9, v27
    v_dot2_f32_bf16 v24, v98, v10, v24
    v_dot2_f32_bf16 v25, v102, v10, v25
    v_dot2_f32_bf16 v26, v106, v10, v26
    v_dot2_f32_bf16 v27, v110, v10, v27
    v_dot2_f32_bf16 v24, v99, v11, v24
    v_dot2_f32_bf16 v25, v103, v11, v25
    v_dot2_f32_bf16 v26, v107, v11, v26
    v_dot2_f32_bf16 v27, v111, v11, v27
    s_cbranch_execz Lw_3
    s_waitcnt vmcnt(1)
Lw_3:
    s_add_u32 s93, s92, 32768
    buffer_load_dwordx4 v[40:43], v1, s[48:51], s93 offen nt
    v_add_f32_dpp v24, v24, v24 row_ror:8 row_mask:0xf bank_mask:0xf
    v_add_f32_dpp v25, v25, v25 row_ror:8 row_mask:0xf bank_mask:0xf
    v_add_f32_dpp v26, v26, v26 row_ror:8 row_mask:0xf bank_mask:0xf
    v_add_f32_dpp v27, v27, v27 row_ror:8 row_mask:0xf bank_mask:0xf
    v_add_f32_dpp v24, v24, v24 row_ror:4 row_mask:0xf bank_mask:0xf
    v_add_f32_dpp v25, v25, v25 row_ror:4 row_mask:0xf bank_mask:0xf
    v_add_f32_dpp v26, v26, v26 row_ror:4 row_mask:0xf bank_mask:0xf
    v_add_f32_dpp v27, v27, v27 row_ror:4 row_mask:0xf bank_mask:0xf
    v_add_f32_dpp v24, v24, v24 row_ror:2 row_mask:0xf bank_mask:0xf
    v_add_f32_dpp v25, v25, v25 row_ror:2 row_mask:0xf bank_mask:0xf
    v_add_f32_dpp v26, v26, v26 row_ror:2 row_mask:0xf bank_mask:0xf
    v_add_f32_dpp v27, v27, v27 row_ror:2 row_mask:0xf bank_mask:0xf
    v_add_f32_dpp v24, v24, v24 row_ror:1 row_mask:0xf bank_mask:0xf
    v_add_f32_dpp v25, v25, v25 row_ror:1 row_mask:0xf bank_mask:0xf
    v_add_f32_dpp v26, v26, v26 row_ror:1 row_mask:0xf bank_mask:0xf
    v_add_f32_dpp v27, v27, v27 row_ror:1 row_mask:0xf bank_mask:0xf
    v_cvt_pk_bf16_f32 v12, v24, v25
    v_lshlrev_b32 v24, 16, v12
    v_and_b32 v25, 0xffff0000, v12
    v_cvt_pk_bf16_f32 v14, v26, v27
    v_lshlrev_b32 v26, 16, v14
    v_and_b32 v27, 0xffff0000, v14
    v_mul_f32 v24, s43, v24
    v_mul_f32 v25, s43, v25
    v_mul_f32 v26, s43, v26
    v_mul_f32 v27, s43, v27
    v_cvt_pk_bf16_f32 v12, v24, v25
    v_lshlrev_b32 v24, 16, v12
    v_and_b32 v25, 0xffff0000, v12
    v_cvt_pk_bf16_f32 v14, v26, v27
    v_lshlrev_b32 v26, 16, v14
    v_and_b32 v27, 0xffff0000, v14
    v_dot2_f32_bf16 v28, v112, v8, 0
    v_dot2_f32_bf16 v29, v116, v8, 0
    v_dot2_f32_bf16 v30, v120, v8, 0
    v_dot2_f32_bf16 v31, v124, v8, 0
    v_dot2_f32_bf16 v28, v113, v9, v28
    v_dot2_f32_bf16 v29, v117, v9, v29
    v_dot2_f32_bf16 v30, v121, v9, v30
    v_dot2_f32_bf16 v31, v125, v9, v31
    v_dot2_f32_bf16 v28, v114, v10, v28
    v_dot2_f32_bf16 v29, v118, v10, v29
    v_dot2_f32_bf16 v30, v122, v10, v30
    v_dot2_f32_bf16 v31, v126, v10, v31
    v_dot2_f32_bf16 v28, v115, v11, v28
    v_dot2_f32_bf16 v29, v119, v11, v29
    v_dot2_f32_bf16 v30, v123, v11, v30
    v_dot2_f32_bf16 v31, v127, v11, v31
    s_add_u32 s93, s94, 5120
    s_mul_i32 s101, s3, 8448
    s_add_u32 m0, s101, 27808
    s_nop 0
    buffer_load_dwordx4 v1, s[56:59], s93 offen nt lds
    v_add_f32_dpp v28, v28, v28 row_ror:8 row_mask:0xf bank_mask:0xf
    v_add_f32_dpp v29, v29, v29 row_ror:8 row_mask:0xf bank_mask:0xf
    v_add_f32_dpp v30, v30, v30 row_ror:8 row_mask:0xf bank_mask:0xf
    v_add_f32_dpp v31, v31, v31 row_ror:8 row_mask:0xf bank_mask:0xf
    v_add_f32_dpp v28, v28, v28 row_ror:4 row_mask:0xf bank_mask:0xf
    v_add_f32_dpp v29, v29, v29 row_ror:4 row_mask:0xf bank_mask:0xf
    v_add_f32_dpp v30, v30, v30 row_ror:4 row_mask:0xf bank_mask:0xf
    v_add_f32_dpp v31, v31, v31 row_ror:4 row_mask:0xf bank_mask:0xf
    v_add_f32_dpp v28, v28, v28 row_ror:2 row_mask:0xf bank_mask:0xf
    v_add_f32_dpp v29, v29, v29 row_ror:2 row_mask:0xf bank_mask:0xf
    v_add_f32_dpp v30, v30, v30 row_ror:2 row_mask:0xf bank_mask:0xf
    v_add_f32_dpp v31, v31, v31 row_ror:2 row_mask:0xf bank_mask:0xf
    v_add_f32_dpp v28, v28, v28 row_ror:1 row_mask:0xf bank_mask:0xf
    v_add_f32_dpp v29, v29, v29 row_ror:1 row_mask:0xf bank_mask:0xf
    v_add_f32_dpp v30, v30, v30 row_ror:1 row_mask:0xf bank_mask:0xf
    v_add_f32_dpp v31, v31, v31 row_ror:1 row_mask:0xf bank_mask:0xf
    v_cvt_pk_bf16_f32 v12, v28, v29
    v_lshlrev_b32 v28, 16, v12
    v_and_b32 v29, 0xffff0000, v12
    v_cvt_pk_bf16_f32 v14, v30, v31
    v_lshlrev_b32 v30, 16, v14
    v_and_b32 v31, 0xffff0000, v14
    v_mul_f32 v28, s43, v28
    v_mul_f32 v29, s43, v29
    v_mul_f32 v30, s43, v30
    v_mul_f32 v31, s43, v31
    v_cvt_pk_bf16_f32 v12, v28, v29
    v_lshlrev_b32 v28, 16, v12
    v_and_b32 v29, 0xffff0000, v12
    v_cvt_pk_bf16_f32 v14, v30, v31
    v_lshlrev_b32 v30, 16, v14
    v_and_b32 v31, 0xffff0000, v14
    s_cbranch_execz L_dryret
L_segSM:
    s_cbranch_execz Lw_4
    s_waitcnt vmcnt(2)
Lw_4:
    s_add_u32 s93, s92, 49152
    buffer_load_dwordx4 v[44:47], v1, s[48:51], s93 offen nt
    v_max3_f32 v12, v16, v17, v18
    v_max3_f32 v13, v19, v20, v21
    v_max3_f32 v14, v22, v23, v24
    v_max3_f32 v15, v25, v26, v27
    v_max3_f32 v12, v12, v28, v29
    v_max3_f32 v13, v13, v30, v31
    v_max3_f32 v12, v12, v13, v14
    v_max_f32 v12, v12, v15
    s_nop 0
    v_readlane_b32 s8, v12, 0
    v_readlane_b32 s9, v12, 16
    v_readlane_b32 s10, v12, 32
    v_readlane_b32 s11, v12, 48
    v_mov_b32 v12, s8
    v_max_f32 v12, s9, v12
    v_max_f32 v12, s10, v12
    v_max_f32 v12, s11, v12
    v_mul_f32 v12, s42, v12
    v_fma_f32 v16, v16, s42, -v12
    v_fma_f32 v17, v17, s42, -v12
    v_fma_f32 v18, v18, s42, -v12
    v_fma_f32 v19, v19, s42, -v12
    v_fma_f32 v20, v20, s42, -v12
    v_fma_f32 v21, v21, s42, -v12
    v_fma_f32 v22, v22, s42, -v12
    v_fma_f32 v23, v23, s42, -v12
    v_fma_f32 v24, v24, s42, -v12
    v_fma_f32 v25, v25, s42, -v12
    v_fma_f32 v26, v26, s42, -v12
    v_fma_f32 v27, v27, s42, -v12
    v_fma_f32 v28, v28, s42, -v12
    v_fma_f32 v29, v29, s42, -v12
    v_fma_f32 v30, v30, s42, -v12
    v_fma_f32 v31, v31, s42, -v12
    v_exp_f32 v16, v16
    v_exp_f32 v17, v17
    v_exp_f32 v18, v18
    v_exp_f32 v19, v19
    v_exp_f32 v20, v20
    v_exp_f32 v21, v21
    v_exp_f32 v22, v22
    v_exp_f32 v23, v23
    v_exp_f32 v24, v24
    v_exp_f32 v25, v25
    v_exp_f32 v26, v26
    v_exp_f32 v27, v27
    v_exp_f32 v28, v28
    v_exp_f32 v29, v29
    v_exp_f32 v30, v30
    v_exp_f32 v31, v31
    s_cbranch_execz Lw_5
    s_waitcnt vmcnt(2)
Lw_5:
    s_add_u32 s93, s92, 65536
    buffer_load_dwordx4 v[48:51], v1, s[48:51], s93 offen nt
    v_readfirstlane_b32 s95, v12
    v_add_f32 v8, v16, v17
    v_add_f32 v9, v18, v19
    v_add_f32 v10, v20, v21
    v_add_f32 v11, v22, v23
    v_add_f32 v13, v24, v25
    v_add_f32 v14, v26, v27
    v_add_f32 v8, v8, v28
    v_add_f32 v9, v9, v29
    v_add_f32 v10, v10, v30
    v_add_f32 v11, v11, v31
    v_add_f32 v8, v8, v9
    v_add_f32 v10, v10, v11
    v_add_f32 v13, v13, v14
    v_add_f32 v8, v8, v10
    v_add_f32 v8, v8, v13
    s_nop 0
    v_readlane_b32 s8, v8, 0
    v_readlane_b32 s9, v8, 16
    v_readlane_b32 s10, v8, 32
    v_readlane_b32 s11, v8, 48
    v_mov_b32 v13, s8
    v_add_f32 v13, s9, v13
    v_add_f32 v13, s10, v13
    v_add_f32 v13, s11, v13
    s_lshl_b32 s8, s3, 3
    v_mov_b32 v8, s8
    s_and_b64 exec, s[98:99], 1
    ds_write_b64 v8, v[12:13] offset:21536
    s_mov_b64 exec, s[98:99]
    v_cvt_pk_bf16_f32 v16, v16, v16
    v_cvt_pk_bf16_f32 v17, v17, v17
    v_cvt_pk_bf16_f32 v18, v18, v18
    v_cvt_pk_bf16_f32 v19, v19, v19
    v_cvt_pk_bf16_f32 v20, v20, v20
    v_cvt_pk_bf16_f32 v21, v21, v21
    v_cvt_pk_bf16_f32 v22, v22, v22
    v_cvt_pk_bf16_f32 v23, v23, v23
    v_cvt_pk_bf16_f32 v24, v24, v24
    v_cvt_pk_bf16_f32 v25, v25, v25
    v_cvt_pk_bf16_f32 v26, v26, v26
    v_cvt_pk_bf16_f32 v27, v27, v27
    v_cvt_pk_bf16_f32 v28, v28, v28
    v_cvt_pk_bf16_f32 v29, v29, v29
    v_cvt_pk_bf16_f32 v30, v30, v30
    v_cvt_pk_bf16_f32 v31, v31, v31
    s_cbranch_execz L_dryret
L_segV0:
    v_and_b32 v8, v16, v4
    v_and_b32 v9, v16, v5
    v_and_b32 v10, v16, v6
    v_and_b32 v11, v16, v7
    s_nop 1
    v_mfma_f32_16x16x32_bf16 v[12:15], v[32:35], v[8:11], 0
    v_and_b32 v8, v17, v4
    v_and_b32 v9, v17, v5
    v_and_b32 v10, v17, v6
    v_and_b32 v11, v17, v7
    s_nop 1
    v_mfma_f32_16x16x32_bf16 v[12:15], v[36:39], v[8:11], v[12:15]
    v_and_b32 v8, v18, v4
    v_and_b32 v9, v18, v5
    v_and_b32 v10, v18, v6
    v_and_b32 v11, v18, v7
    s_nop 1
    v_mfma_f32_16x16x32_bf16 v[12:15], v[40:43], v[8:11], v[12:15]
    s_cbranch_execz Lw_6
    s_waitcnt vmcnt(1)
Lw_6:
    s_add_u32 s93, s92, 81920
    buffer_load_dwordx4 v[52:55], v1, s[48:51], s93 offen nt
    v_and_b32 v8, v19, v4
    v_and_b32 v9, v19, v5
    v_and_b32 v10, v19, v6
    v_and_b32 v11, v19, v7
    s_nop 1
    v_mfma_f32_16x16x32_bf16 v[12:15], v[44:47], v[8:11], v[12:15]
    s_add_u32 s93, s94, 6144
    s_mul_i32 s101, s3, 8448
    s_add_u32 m0, s101, 28864
    s_nop 0
    buffer_load_dwordx4 v1, s[56:59], s93 offen nt lds
    s_cbranch_execz Lw_7
    s_waitcnt vmcnt(2)
Lw_7:
    s_add_u32 s93, s92, 98304
    buffer_load_dwordx4 v[56:59], v1, s[48:51], s93 offen nt
    v_and_b32 v8, v20, v4
    v_and_b32 v9, v20, v5
    v_and_b32 v10, v20, v6
    v_and_b32 v11, v20, v7
    s_nop 1
    v_mfma_f32_16x16x32_bf16 v[12:15], v[48:51], v[8:11], v[12:15]
    s_cbranch_execz Lw_8
    s_waitcnt vmcnt(2)
Lw_8:
    s_add_u32 s93, s92, 114688
    buffer_load_dwordx4 v[60:63], v1, s[48:51], s93 offen nt
    v_and_b32 v8, v21, v4
    v_and_b32 v9, v21, v5
    v_and_b32 v10, v21, v6
    v_and_b32 v11, v21, v7
    s_nop 1
    v_mfma_f32_16x16x32_bf16 v[12:15], v[52:55], v[8:11], v[12:15]
    s_cbranch_execz Lw_9
    s_waitcnt vmcnt(1)
Lw_9:
    s_add_u32 s93, s92, 131072
    buffer_load_dwordx4 v[64:67], v1, s[48:51], s93 offen nt
    v_and_b32 v8, v22, v4
    v_and_b32 v9, v22, v5
    v_and_b32 v10, v22, v6
    v_and_b32 v11, v22, v7
    s_nop 1
    v_mfma_f32_16x16x32_bf16 v[12:15], v[56:59], v[8:11], v[12:15]
    s_add_u32 s93, s94, 7168
    s_mul_i32 s101, s3, 8448
    s_add_u32 m0, s101, 29920
    s_nop 0
    buffer_load_dwordx4 v1, s[56:59], s93 offen nt lds
    s_cbranch_execz Lw_10
    s_waitcnt vmcnt(2)
Lw_10:
    s_add_u32 s93, s92, 147456
    buffer_load_dwordx4 v[68:71], v1, s[48:51], s93 offen nt
    v_and_b32 v8, v23, v4
    v_and_b32 v9, v23, v5
    v_and_b32 v10, v23, v6
    v_and_b32 v11, v23, v7
    s_nop 1
    v_mfma_f32_16x16x32_bf16 v[12:15], v[60:63], v[8:11], v[12:15]
    s_cbranch_execz Lw_11
    s_waitcnt vmcnt(2)
Lw_11:
    s_add_u32 s93, s92, 163840
    buffer_load_dwordx4 v[72:75], v1, s[48:51], s93 offen nt
    v_and_b32 v8, v24, v4
    v_and_b32 v9, v24, v5
    v_and_b32 v10, v24, v6
    v_and_b32 v11, v24, v7
    s_nop 1
    v_mfma_f32_16x16x32_bf16 v[12:15], v[64:67], v[8:11], v[12:15]
    s_cbranch_execz L_dryret
L_segV9:
    s_cbranch_execz Lw_12
    s_waitcnt vmcnt(1)
Lw_12:
    s_add_u32 s93, s92, 180224
    buffer_load_dwordx4 v[76:79], v1, s[48:51], s93 offen nt
    v_and_b32 v8, v25, v4
    v_and_b32 v9, v25, v5
    v_and_b32 v10, v25, v6
    v_and_b32 v11, v25, v7
    s_nop 1
    v_mfma_f32_16x16x32_bf16 v[12:15], v[68:71], v[8:11], v[12:15]
    s_cbranch_execz Lw_13
    s_waitcnt vmcnt(1)
Lw_13:
    s_add_u32 s93, s92, 196608
    buffer_load_dwordx4 v[80:83], v1, s[48:51], s93 offen nt
    v_and_b32 v8, v26, v4
    v_and_b32 v9, v26, v5
    v_and_b32 v10, v26, v6
    v_and_b32 v11, v26, v7
    s_nop 1
    v_mfma_f32_16x16x32_bf16 v[12:15], v[72:75], v[8:11], v[12:15]
    v_and_b32 v3, 15, v0
    v_lshlrev_b32 v3, 3, v3
    s_mov_b32 s29, 0
    s_nop 4
L_stspin:
    ds_read_b64 v[32:33], v3 offset:21536
    s_waitcnt lgkmcnt(0)
    v_max_u32 v34, v32, v33
    v_cmp_eq_u32 vcc, -1, v34
    s_add_u32 s29, s29, 1
    s_cmp_eq_u64 vcc, 0
    s_cbranch_scc1 L_stok
    s_cmp_lt_u32 s29, 200000
    s_sleep 1
    s_cbranch_scc1 L_stspin
L_stok:
    v_mov_b32 v40, v32
    s_nop 1
    v_max_f32_dpp v40, v40, v40 row_ror:8 row_mask:0xf bank_mask:0xf
    s_nop 1
    v_max_f32_dpp v40, v40, v40 row_ror:4 row_mask:0xf bank_mask:0xf
    s_nop 1
    v_max_f32_dpp v40, v40, v40 row_ror:2 row_mask:0xf bank_mask:0xf
    s_nop 1
    v_max_f32_dpp v40, v40, v40 row_ror:1 row_mask:0xf bank_mask:0xf
    v_sub_f32 v41, v32, v40
    v_exp_f32 v41, v41
    v_sub_f32 v35, s95, v40
    v_mul_f32 v41, v41, v33
    v_exp_f32 v35, v35
    s_nop 0
    v_add_f32_dpp v41, v41, v41 row_ror:8 row_mask:0xf bank_mask:0xf
    s_nop 1
    v_add_f32_dpp v41, v41, v41 row_ror:4 row_mask:0xf bank_mask:0xf
    s_nop 1
    v_add_f32_dpp v41, v41, v41 row_ror:2 row_mask:0xf bank_mask:0xf
    s_nop 1
    v_add_f32_dpp v41, v41, v41 row_ror:1 row_mask:0xf bank_mask:0xf
    s_cmp_lg_u32 s3, 0
    s_cbranch_scc1 L_nostat
    v_mov_b32 v42, s40
    v_mov_b32 v43, s41
    s_lshl_b32 s7, s5, 7
    s_lshl_b32 s8, s4, 2
    s_add_u32 s7, s7, s8
    s_add_u32 s7, s7, s6
    s_lshl_b32 s7, s7, 4
    v_mov_b32 v34, 0
    s_and_b64 exec, s[98:99], 1
    buffer_store_dwordx4 v[40:43], v34, s[64:67], s7 offen sc1
    s_mov_b64 exec, s[98:99]
L_nostat:
    v_lshrrev_b32 v39, 4, v0
    v_bfe_u32 v37, v0, 2, 1
    v_lshlrev_b32 v36, 6, v39
    v_lshl_add_u32 v36, v37, 4, v36
    v_and_b32 v37, 3, v0
    v_lshl_add_u32 v36, v37, 1, v36
    s_mul_i32 s7, s3, 272
    v_add_u32 v36, s7, v36
    v_and_b32 v37, 15, v0
    v_mul_u32_u24 v37, 272, v37
    v_lshl_add_u32 v37, v39, 4, v37
    v_and_b32 v38, 7, v0
    v_lshlrev_b32 v38, 4, v38
    v_bfe_u32 v34, v0, 4, 1
    v_lshl_add_u32 v38, v34, 3, v38
    v_bfe_u32 v34, v0, 3, 1
    v_lshl_add_u32 v38, v34, 2, v38
    s_lshl_b32 s27, s5, 7
    s_lshl_b32 s8, s4, 2
    s_add_u32 s27, s27, s8
    s_add_u32 s27, s27, s6
    s_lshl_b32 s27, s27, 11
    s_lshl_b32 s8, s3, 7
    s_add_u32 s27, s27, s8
    s_add_u32 s27, s27, 0x10000
    s_mov_b32 s12, 0xffff0000
    s_mov_b32 s13, 0
    s_mov_b32 s14, 0x00ff00ff
    s_mov_b32 s15, 0x00ff00ff
    s_cbranch_execz Lw_14
    s_waitcnt vmcnt(1)
Lw_14:
    s_add_u32 s93, s92, 212992
    buffer_load_dwordx4 v[84:87], v1, s[48:51], s93 offen nt
    v_and_b32 v8, v27, v4
    v_and_b32 v9, v27, v5
    v_and_b32 v10, v27, v6
    v_and_b32 v11, v27, v7
    s_nop 1
    v_mfma_f32_16x16x32_bf16 v[12:15], v[76:79], v[8:11], v[12:15]
    s_cbranch_execz L_dryret
L_segV12:
    s_cbranch_execz Lw_15
    s_waitcnt vmcnt(1)
Lw_15:
    s_add_u32 s93, s92, 229376
    buffer_load_dwordx4 v[88:91], v1, s[48:51], s93 offen nt
    v_and_b32 v8, v28, v4
    v_and_b32 v9, v28, v5
    v_and_b32 v10, v28, v6
    v_and_b32 v11, v28, v7
    s_nop 1
    v_mfma_f32_16x16x32_bf16 v[12:15], v[80:83], v[8:11], v[12:15]
    s_cbranch_execz Lw_16
    s_waitcnt vmcnt(1)
Lw_16:
    s_add_u32 s93, s92, 245760
    buffer_load_dwordx4 v[92:95], v1, s[48:51], s93 offen nt
    v_and_b32 v8, v29, v4
    v_and_b32 v9, v29, v5
    v_and_b32 v10, v29, v6
    v_and_b32 v11, v29, v7
    s_nop 1
    v_mfma_f32_16x16x32_bf16 v[12:15], v[84:87], v[8:11], v[12:15]
    v_lshrrev_b32 v3, 2, v0
    v_mul_u32_u24 v3, 1056, v3
    v_and_b32 v8, 3, v0
    v_lshl_add_u32 v3, v8, 3, v3
    s_lshl_b32 s7, s3, 6
    v_add_u32 v3, s7, v3
    s_cbranch_execz Lb_17
    s_barrier
Lb_17:
    s_cbranch_execz L_notr
    ds_read_b64_tr_b16 v[96:97], v3 offset:22528
    ds_read_b64_tr_b16 v[98:99], v3 offset:39424
    ds_read_b64_tr_b16 v[112:113], v3 offset:22560
    ds_read_b64_tr_b16 v[114:115], v3 offset:39456
    v_add_u32 v3, 33792, v3
    ds_read_b64_tr_b16 v[100:101], v3 offset:22528
    ds_read_b64_tr_b16 v[102:103], v3 offset:39424
    ds_read_b64_tr_b16 v[116:117], v3 offset:22560
    ds_read_b64_tr_b16 v[118:119], v3 offset:39456
    v_add_u32 v3, 33792, v3
    ds_read_b64_tr_b16 v[104:105], v3 offset:22528
    ds_read_b64_tr_b16 v[106:107], v3 offset:39424
    ds_read_b64_tr_b16 v[120:121], v3 offset:22560
    ds_read_b64_tr_b16 v[122:123], v3 offset:39456
    v_add_u32 v3, 33792, v3
    ds_read_b64_tr_b16 v[108:109], v3 offset:22528
    ds_read_b64_tr_b16 v[110:111], v3 offset:39424
    ds_read_b64_tr_b16 v[124:125], v3 offset:22560
    ds_read_b64_tr_b16 v[126:127], v3 offset:39456
L_notr:
    v_and_b32 v8, v30, v4
    v_and_b32 v9, v30, v5
    v_and_b32 v10, v30, v6
    v_and_b32 v11, v30, v7
    s_cbranch_execz Lw_18
    s_waitcnt vmcnt(1)
Lw_18:
    v_mfma_f32_16x16x32_bf16 v[12:15], v[88:91], v[8:11], v[12:15]
    s_cmp_lt_u32 s2, 224
    s_cbranch_scc1 L_norchk
    v_lshrrev_b32 v52, 3, v0
    s_lshl_b32 s7, s3, 3
    v_add_u32 v52, s7, v52
    v_and_b32 v53, 7, v52
    v_bfe_u32 v54, v52, 3, 2
    v_lshl_add_u32 v53, v53, 2, v54
    v_lshrrev_b32 v54, 5, v52
    v_lshl_add_u32 v53, v53, 2, v54
    v_lshlrev_b32 v53, 4, v53
    v_lshlrev_b32 v54, 4, v52
    s_lshr_b32 s7, s97, 4
    s_lshl_b32 s7, s7, 11
    v_add_u32 v54, s7, v54
    buffer_load_dwordx4 v[56:59], v53, s[64:67], 0 offen sc1
    buffer_load_dwordx4 v[60:63], v54, s[64:67], 0 offen sc1
L_norchk:
    v_and_b32 v8, v31, v4
    v_and_b32 v9, v31, v5
    v_and_b32 v10, v31, v6
    v_and_b32 v11, v31, v7
    s_cbranch_execz Lw_19
    s_waitcnt vmcnt(0)
Lw_19:
    v_mfma_f32_16x16x32_bf16 v[12:15], v[92:95], v[8:11], v[12:15]
    s_cbranch_execz L_dryret
L_segA:
    s_nop 6
    v_mul_f32 v12, v12, v35
    v_mul_f32 v13, v13, v35
    v_mul_f32 v14, v14, v35
    v_mul_f32 v15, v15, v35
    v_cvt_pk_bf16_f32 v12, v12, v13
    v_cvt_pk_bf16_f32 v14, v14, v15
    s_and_b64 exec, s[98:99], s[14:15]
    ds_write_b16 v36, v12 offset:0
    ds_write_b16_d16_hi v36, v12 offset:32
    ds_write_b16 v36, v14 offset:8
    ds_write_b16_d16_hi v36, v14 offset:40
    s_mov_b64 exec, s[98:99]
    s_waitcnt lgkmcnt(0)
    s_cbranch_execz Lb_20
    s_barrier
Lb_20:
    ds_read_b128 v[64:67], v37 offset:0
    ds_read_b128 v[68:71], v37 offset:64
    ds_read_b128 v[72:75], v37 offset:128
    ds_read_b128 v[76:79], v37 offset:192
    s_cbranch_execz L_dryret
L_segB:
    s_waitcnt lgkmcnt(3)
    v_mfma_f32_16x16x32_bf16 v[12:15], v[64:67], v[96:99], 0
    v_mfma_f32_16x16x32_bf16 v[8:11], v[64:67], v[112:115], 0
    s_waitcnt lgkmcnt(2)
    v_mfma_f32_16x16x32_bf16 v[12:15], v[68:71], v[100:103], v[12:15]
    v_mfma_f32_16x16x32_bf16 v[8:11], v[68:71], v[116:119], v[8:11]
    s_waitcnt lgkmcnt(1)
    v_mfma_f32_16x16x32_bf16 v[12:15], v[72:75], v[104:107], v[12:15]
    v_mfma_f32_16x16x32_bf16 v[8:11], v[72:75], v[120:123], v[8:11]
    s_waitcnt lgkmcnt(0)
    v_mfma_f32_16x16x32_bf16 v[12:15], v[76:79], v[108:111], v[12:15]
    v_mfma_f32_16x16x32_bf16 v[8:11], v[76:79], v[124:127], v[8:11]
    s_nop 6
    v_add_f32 v12, v12, v13
    v_add_f32 v14, v14, v15
    v_add_f32 v8, v8, v9
    v_add_f32 v10, v10, v11
    v_add_f32 v12, v12, v14
    v_add_f32 v8, v8, v10
    v_mov_b32 v13, v12
    v_mov_b32 v9, v8
    s_nop 0
    v_permlane16_swap_b32 v12, v13
    v_permlane16_swap_b32 v8, v9
    v_add_f32 v12, v12, v13
    v_add_f32 v8, v8, v9
    v_mov_b32 v13, v12
    v_mov_b32 v9, v8
    s_nop 0
    v_permlane32_swap_b32 v12, v13
    v_permlane32_swap_b32 v8, v9
    v_add_f32 v12, v12, v13
    v_add_f32 v8, v8, v9
    v_cndmask_b32 v12, v12, v8, s[12:13]
    s_mov_b32 exec_hi, 0
    s_mov_b32 exec_lo, s98
    buffer_store_dword v12, v38, s[64:67], s27 offen sc1
    s_mov_b64 exec, s[98:99]
    s_cbranch_execz L_dryret
    s_cmp_ge_u32 s2, 224
    s_cbranch_scc1 L_segH
    s_cmp_ge_u32 s2, 86
    s_cbranch_scc1 L_fin
    s_cmp_lt_u32 s3, 4
    s_cbranch_scc1 L_fin
    s_cmp_gt_u32 s3, 8
    s_cbranch_scc1 L_fin
    s_cmp_eq_u32 s3, 8
    s_cbranch_scc1 L_segF
L_segC:
    s_and_b32 s28, s3, 3
    v_lshrrev_b32 v18, 4, v0
    v_and_b32 v20, 1, v0
    v_lshlrev_b32 v20, 10, v20
    v_lshl_add_u32 v20, v18, 4, v20
    s_lshl_b32 s24, s28, 8
    v_add_u32 v20, s24, v20
    v_and_b32 v21, 3, v0
    v_lshlrev_b32 v21, 4, v21
    v_bfe_u32 v22, v0, 2, 2
    v_lshl_add_u32 v21, v22, 2, v21
    s_lshl_b32 s24, s28, 6
    v_add_u32 v22, s24, v21
    s_lshl_b32 s24, s28, 7
    v_add_u32 v21, s24, v21
    v_bfe_u32 v23, v0, 3, 1
    v_lshlrev_b32 v28, 3, v23
    v_lshlrev_b32 v23, 6, v23
    v_lshl_add_u32 v23, v18, 4, v23
    v_lshlrev_b32 v19, 4, v18
    v_bfe_u32 v29, v0, 3, 1
    v_lshlrev_b32 v29, 11, v29
    v_lshl_add_u32 v29, v18, 7, v29
    v_and_b32 v30, 7, v0
    v_lshl_add_u32 v29, v30, 4, v29
    s_lshl_b32 s27, s2, 12
    s_lshl_b32 s25, s28, 9
    s_add_u32 s27, s27, s25
    s_add_u32 s27, s27, 0x100000
    v_bfe_u32 v31, v0, 2, 2
    v_lshlrev_b32 v31, 8, v31
    v_lshl_add_u32 v31, v18, 6, v31
    v_and_b32 v17, 3, v0
    v_lshl_add_u32 v31, v17, 3, v31
    s_lshl_b32 s24, s28, 12
    v_add_u32 v31, s24, v31
    v_mov_b32 v8, 0x3f803f80
    v_mov_b32 v9, 0x3f803f80
    v_mov_b32 v10, 0x3f803f80
    v_mov_b32 v11, 0x3f803f80
    v_lshrrev_b32 v16, 1, v0
    s_movk_i32 s24, 2752
    v_mul_lo_u32 v16, v16, s24
    v_and_b32 v17, 1, v0
    v_lshl_add_u32 v16, v17, 4, v16
    s_mul_i32 s24, s28, 352256
    s_lshl_b32 s25, s2, 5
    s_add_u32 s24, s24, s25
    s_lshl_b32 s25, s28, 12
    s_add_u32 s25, s25, 23552
    s_mov_b32 m0, s25
    s_nop 0
    buffer_load_dwordx4 v16, s[72:75], s24 offen lds
    s_add_u32 s24, s24, 88064
    s_add_u32 s25, s25, 1024
    s_mov_b32 m0, s25
    s_nop 0
    buffer_load_dwordx4 v16, s[72:75], s24 offen lds
    s_add_u32 s24, s24, 88064
    s_add_u32 s25, s25, 1024
    s_mov_b32 m0, s25
    s_nop 0
    buffer_load_dwordx4 v16, s[72:75], s24 offen lds
    s_add_u32 s24, s24, 88064
    s_add_u32 s25, s25, 1024
    s_mov_b32 m0, s25
    s_nop 0
    buffer_load_dwordx4 v16, s[72:75], s24 offen lds
    v_and_b32 v17, 15, v0
    v_lshlrev_b32 v17, 4, v17
    v_lshl_add_u32 v17, v18, 10, v17
    s_lshl_b32 s24, s2, 14
    s_lshl_b32 s25, s28, 8
    s_add_u32 s24, s24, s25
    buffer_load_dwordx4 v[48:51], v17, s[76:79], s24 offen
    s_add_u32 s24, s24, 4096
    buffer_load_dwordx4 v[52:55], v17, s[76:79], s24 offen
    s_add_u32 s24, s24, 4096
    buffer_load_dwordx4 v[56:59], v17, s[76:79], s24 offen
    s_add_u32 s24, s24, 4096
    buffer_load_dwordx4 v[60:63], v17, s[76:79], s24 offen
    v_lshlrev_b32 v17, 1, v18
    s_lshl_b32 s24, s2, 5
    buffer_load_ushort v24, v17, s[80:83], s24 offen
    buffer_load_ushort v25, v17, s[80:83], s24 offen offset:8
    buffer_load_ushort v26, v17, s[80:83], s24 offen offset:16
    buffer_load_ushort v27, v17, s[80:83], s24 offen offset:24
    s_cbranch_execz Lw_21
    s_waitcnt vmcnt(0)
Lw_21:
    s_cbranch_execz L_c3
    ds_read_b64_tr_b16 v[64:65], v31 offset:23552
    ds_read_b64_tr_b16 v[66:67], v31 offset:23584
    ds_read_b64_tr_b16 v[68:69], v31 offset:24576
    ds_read_b64_tr_b16 v[70:71], v31 offset:24608
    ds_read_b64_tr_b16 v[72:73], v31 offset:25600
    ds_read_b64_tr_b16 v[74:75], v31 offset:25632
    ds_read_b64_tr_b16 v[76:77], v31 offset:26624
    ds_read_b64_tr_b16 v[78:79], v31 offset:26656
L_c3:
    s_waitcnt lgkmcnt(6)
    v_mfma_f32_16x16x32_bf16 v[12:15], v[8:11], v[64:67], 0
    s_waitcnt lgkmcnt(4)
    v_mfma_f32_16x16x32_bf16 v[12:15], v[8:11], v[68:71], v[12:15]
    s_waitcnt lgkmcnt(2)
    v_mfma_f32_16x16x32_bf16 v[12:15], v[8:11], v[72:75], v[12:15]
    s_waitcnt lgkmcnt(0)
    v_mfma_f32_16x16x32_bf16 v[12:15], v[8:11], v[76:79], v[12:15]
    v_lshlrev_b32 v24, 16, v24
    v_lshlrev_b32 v25, 16, v25
    v_lshlrev_b32 v26, 16, v26
    v_lshlrev_b32 v27, 16, v27
    s_and_b64 exec, s[98:99], 0xffff
    s_nop 2
    ds_write_b32 v22, v12 offset:21248
    s_mov_b64 exec, s[98:99]
    s_waitcnt lgkmcnt(0)
    s_cbranch_execz L_dryret
L_segD:
    s_cbranch_execz Lb_22
    s_barrier
Lb_22:
    ds_read_b128 v[32:35], v20 offset:39936
    ds_read_b128 v[36:39], v20 offset:40000
    ds_read_b128 v[40:43], v20 offset:40064
    ds_read_b128 v[44:47], v20 offset:40128
    ds_read_b128 v[80:83], v19 offset:21248
    ds_read_b128 v[84:87], v19 offset:21312
    ds_read_b128 v[88:91], v19 offset:21376
    ds_read_b128 v[92:95], v19 offset:21440
    s_waitcnt lgkmcnt(7)
    v_mfma_f32_16x16x32_bf16 v[12:15], v[32:35], v[64:67], 0
    s_waitcnt lgkmcnt(6)
    v_mfma_f32_16x16x32_bf16 v[12:15], v[36:39], v[68:71], v[12:15]
    s_waitcnt lgkmcnt(5)
    v_mfma_f32_16x16x32_bf16 v[12:15], v[40:43], v[72:75], v[12:15]
    s_waitcnt lgkmcnt(4)
    v_mfma_f32_16x16x32_bf16 v[12:15], v[44:47], v[76:79], v[12:15]
    s_waitcnt lgkmcnt(2)
    v_add_f32 v80, v80, v84
    s_waitcnt lgkmcnt(0)
    v_add_f32 v88, v88, v92
    v_add_f32 v81, v81, v85
    v_add_f32 v89, v89, v93
    v_add_f32 v82, v82, v86
    v_add_f32 v90, v90, v94
    v_add_f32 v83, v83, v87
    v_add_f32 v91, v91, v95
    v_add_f32 v80, v80, v88
    v_add_f32 v81, v81, v89
    v_add_f32 v82, v82, v90
    v_add_f32 v83, v83, v91
    s_and_b64 exec, s[98:99], 0xffff
    ds_write_b32 v21, v12 offset:20736
    ds_write_b32 v21, v13 offset:20800
    s_mov_b64 exec, s[98:99]
    s_mov_b32 s24, 0xbdd2d3e8
    v_mov_b32 v31, 0xc0135761
    s_waitcnt lgkmcnt(0)
    s_cbranch_execz Lb_23
    s_barrier
Lb_23:
    s_cbranch_execz L_dryret
L_segE:
    ds_read_b128 v[96:99], v23 offset:20736
    ds_read_b128 v[100:103], v23 offset:20864
    ds_read_b128 v[104:107], v23 offset:20992
    ds_read_b128 v[108:111], v23 offset:21120
    ds_read_b64 v[112:113], v28 offset:21504
    s_waitcnt lgkmcnt(3)
    v_add_f32 v96, v96, v100
    s_waitcnt lgkmcnt(1)
    v_add_f32 v104, v104, v108
    v_add_f32 v97, v97, v101
    v_add_f32 v105, v105, v109
    v_add_f32 v98, v98, v102
    v_add_f32 v106, v106, v110
    v_add_f32 v99, v99, v103
    v_add_f32 v107, v107, v111
    v_add_f32 v96, v96, v104
    v_add_f32 v97, v97, v105
    v_add_f32 v98, v98, v106
    v_add_f32 v99, v99, v107
    s_waitcnt lgkmcnt(0)
    v_fma_f32 v96, -v112, v80, v96
    v_fma_f32 v97, -v112, v81, v97
    v_fma_f32 v98, -v112, v82, v98
    v_fma_f32 v99, -v112, v83, v99
    v_mul_f32 v96, v96, v113
    v_mul_f32 v97, v97, v113
    v_mul_f32 v98, v98, v113
    v_mul_f32 v99, v99, v113
    v_cvt_pk_bf16_f32 v100, v96, v97
    v_lshlrev_b32 v96, 16, v100
    v_and_b32 v97, 0xffff0000, v100
    v_cvt_pk_bf16_f32 v101, v98, v99
    v_lshlrev_b32 v98, 16, v101
    v_and_b32 v99, 0xffff0000, v101
    v_add_f32 v96, v96, v24
    v_add_f32 v97, v97, v25
    v_add_f32 v98, v98, v26
    v_add_f32 v99, v99, v27
    v_cvt_pk_bf16_f32 v100, v96, v97
    v_lshlrev_b32 v96, 16, v100
    v_and_b32 v97, 0xffff0000, v100
    v_cvt_pk_bf16_f32 v101, v98, v99
    v_lshlrev_b32 v98, 16, v101
    v_and_b32 v99, 0xffff0000, v101
    v_mul_f32 v100, v96, v96
    v_mul_f32 v101, v97, v97
    v_mul_f32 v102, v98, v98
    v_mul_f32 v103, v99, v99
    v_fma_f32 v100, v100, s24, v31
    v_fma_f32 v101, v101, s24, v31
    v_fma_f32 v102, v102, s24, v31
    v_fma_f32 v103, v103, s24, v31
    v_mul_f32 v100, v100, v96
    v_mul_f32 v101, v101, v97
    v_mul_f32 v102, v102, v98
    v_mul_f32 v103, v103, v99
    v_exp_f32 v100, v100
    v_exp_f32 v101, v101
    v_exp_f32 v102, v102
    v_exp_f32 v103, v103
    v_add_f32 v100, 1.0, v100
    v_add_f32 v101, 1.0, v101
    v_add_f32 v102, 1.0, v102
    v_add_f32 v103, 1.0, v103
    v_rcp_f32 v100, v100
    v_rcp_f32 v101, v101
    v_rcp_f32 v102, v102
    v_rcp_f32 v103, v103
    v_mul_f32 v96, v96, v100
    v_mul_f32 v97, v97, v101
    v_mul_f32 v98, v98, v102
    v_mul_f32 v99, v99, v103
    v_cvt_pk_bf16_f32 v96, v96, v96
    v_cvt_pk_bf16_f32 v97, v97, v97
    v_cvt_pk_bf16_f32 v98, v98, v98
    v_cvt_pk_bf16_f32 v99, v99, v99
    v_and_b32 v8, v96, v4
    v_and_b32 v9, v96, v5
    v_and_b32 v10, v96, v6
    v_and_b32 v11, v96, v7
    s_nop 1
    v_mfma_f32_16x16x32_bf16 v[12:15], v[48:51], v[8:11], 0
    v_and_b32 v8, v97, v4
    v_and_b32 v9, v97, v5
    v_and_b32 v10, v97, v6
    v_and_b32 v11, v97, v7
    s_nop 1
    v_mfma_f32_16x16x32_bf16 v[12:15], v[52:55], v[8:11], v[12:15]
    v_and_b32 v8, v98, v4
    v_and_b32 v9, v98, v5
    v_and_b32 v10, v98, v6
    v_and_b32 v11, v98, v7
    s_nop 1
    v_mfma_f32_16x16x32_bf16 v[12:15], v[56:59], v[8:11], v[12:15]
    v_and_b32 v8, v99, v4
    v_and_b32 v9, v99, v5
    v_and_b32 v10, v99, v6
    v_and_b32 v11, v99, v7
    s_nop 1
    v_mfma_f32_16x16x32_bf16 v[12:15], v[60:63], v[8:11], v[12:15]
    s_nop 7
    buffer_store_dwordx4 v[12:15], v29, s[64:67], s27 offen sc1
    s_cbranch_execz L_dryret
    s_branch L_fin
L_segF:
    s_mov_b32 s24, 0x8000
    v_mov_b32 v28, 0
    v_lshlrev_b32 v29, 3, v0
    v_and_b32 v30, 31, v0
    v_lshlrev_b32 v30, 6, v30
    s_movk_i32 s25, 2096
    s_mov_b64 s[16:17], s[98:99]
    s_mov_b32 s29, 0
Lpt_24:
    s_mov_b64 exec, s[16:17]
    buffer_load_dwordx4 v[32:35], v30, s[64:67], s25 offen sc1
    s_mov_b64 exec, s[98:99]
    s_cbranch_execz Lw_27
    s_waitcnt vmcnt(0)
Lw_27:
Lptchk_26:
    s_mov_b64 exec, s[16:17]
    v_cmp_ne_u64 s[16:17], s[40:41], v[34:35]
    s_or_b64 s[100:101], s[16:17], s[16:17]
    s_cbranch_scc0 Lptdone_25
    s_add_u32 s29, s29, 1
    s_cmp_lt_u32 s29, 200000
    s_cbranch_scc0 Lptdone_25
    s_sleep 2
    s_branch Lpt_24
Lptdone_25:
    s_mov_b64 exec, s[98:99]
    s_and_b64 exec, s[98:99], 0x200000
    s_mov_b32 s29, 0
    s_cbranch_execz Lp1done_29
Lp1_28:
    buffer_load_dword v31, v1, s[64:67], s24 offen offset:2060 sc1
    s_waitcnt vmcnt(0)
    v_cmp_eq_u32 vcc, -1, v31
    s_add_u32 s29, s29, 1
    s_cmp_eq_u64 vcc, 0
    s_cbranch_scc1 Lp1done_29
    s_cmp_lt_u32 s29, 200000
    s_cbranch_scc1 Lp1_28
Lp1done_29:
    s_mov_b64 exec, s[98:99]
    s_mov_b64 s[16:17], s[98:99]
    s_mov_b64 s[18:19], s[98:99]
    s_mov_b64 s[20:21], s[98:99]
    s_mov_b64 s[22:23], s[98:99]
    s_mov_b32 s29, 0
Lpoll_30:
    s_mov_b64 exec, s[16:17]
    buffer_load_dwordx4 v[32:35], v1, s[64:67], s24 offen sc1
    s_mov_b64 exec, s[18:19]
    buffer_load_dwordx4 v[36:39], v1, s[64:67], s24 offen offset:1024 sc1
    s_mov_b64 exec, s[20:21]
    buffer_load_dwordx4 v[40:43], v1, s[64:67], s24 offen offset:2048 sc1
    s_mov_b64 exec, s[22:23]
    buffer_load_dwordx4 v[44:47], v1, s[64:67], s24 offen offset:3072 sc1
    s_mov_b64 exec, s[98:99]
    s_cbranch_execz Lw_32
    s_waitcnt vmcnt(0)
Lw_32:
    s_mov_b64 exec, s[16:17]
    v_max3_u32 v31, v32, v33, v34
    v_max_u32 v31, v31, v35
    v_cmp_eq_u32 s[16:17], -1, v31
    s_mov_b64 exec, s[18:19]
    v_max3_u32 v31, v36, v37, v38
    v_max_u32 v31, v31, v39
    v_cmp_eq_u32 s[18:19], -1, v31
    s_mov_b64 exec, s[20:21]
    v_max3_u32 v31, v40, v41, v42
    v_max_u32 v31, v31, v43
    v_cmp_eq_u32 s[20:21], -1, v31
    s_mov_b64 exec, s[22:23]
    v_max3_u32 v31, v44, v45, v46
    v_max_u32 v31, v31, v47
    v_cmp_eq_u32 s[22:23], -1, v31
    s_or_b64 s[100:101], s[16:17], s[18:19]
    s_or_b64 s[100:101], s[100:101], s[20:21]
    s_or_b64 s[100:101], s[100:101], s[22:23]
    s_cbranch_scc0 Lpolldone_31
    s_add_u32 s29, s29, 1
    s_cmp_lt_u32 s29, 200000
    s_cbranch_scc0 Lpolldone_31
    s_sleep 1
    s_branch Lpoll_30
Lpolldone_31:
    s_mov_b64 exec, s[98:99]
    v_cvt_pk_bf16_f32 v16, v32, v33
    v_cvt_pk_bf16_f32 v17, v34, v35
    v_cvt_pk_bf16_f32 v18, v36, v37
    v_cvt_pk_bf16_f32 v19, v38, v39
    v_cvt_pk_bf16_f32 v20, v40, v41
    v_cvt_pk_bf16_f32 v21, v42, v43
    v_cvt_pk_bf16_f32 v22, v44, v45
    v_cvt_pk_bf16_f32 v23, v46, v47
    ds_write_b64 v29, v[16:17] offset:39936
    ds_write_b64 v29, v[18:19] offset:40448
    ds_write_b64 v29, v[20:21] offset:40960
    ds_write_b64 v29, v[22:23] offset:41472
    v_readlane_b32 s16, v32, 0
    v_readlane_b32 s17, v40, 0
    s_waitcnt lgkmcnt(0)
    s_cbranch_execz Lb_33
    s_barrier
Lb_33:
    v_subrev_f32 v32, s16, v32
    v_subrev_f32 v33, s16, v33
    v_subrev_f32 v34, s16, v34
    v_subrev_f32 v35, s16, v35
    v_subrev_f32 v36, s16, v36
    v_subrev_f32 v37, s16, v37
    v_subrev_f32 v38, s16, v38
    v_subrev_f32 v39, s16, v39
    v_subrev_f32 v40, s17, v40
    v_subrev_f32 v41, s17, v41
    v_subrev_f32 v42, s17, v42
    v_subrev_f32 v43, s17, v43
    v_subrev_f32 v44, s17, v44
    v_subrev_f32 v45, s17, v45
    v_subrev_f32 v46, s17, v46
    v_subrev_f32 v47, s17, v47
    v_add_f32 v8, v32, v33
    v_mul_f32 v9, v32, v32
    v_fmac_f32 v9, v33, v33
    v_add_f32 v10, v40, v41
    v_mul_f32 v11, v40, v40
    v_fmac_f32 v11, v41, v41
    v_add_f32 v8, v8, v34
    v_fmac_f32 v9, v34, v34
    v_add_f32 v10, v10, v42
    v_fmac_f32 v11, v42, v42
    v_add_f32 v8, v8, v35
    v_fmac_f32 v9, v35, v35
    v_add_f32 v10, v10, v43
    v_fmac_f32 v11, v43, v43
    v_add_f32 v8, v8, v36
    v_fmac_f32 v9, v36, v36
    v_add_f32 v10, v10, v44
    v_fmac_f32 v11, v44, v44
    v_add_f32 v8, v8, v37
    v_fmac_f32 v9, v37, v37
    v_add_f32 v10, v10, v45
    v_fmac_f32 v11, v45, v45
    v_add_f32 v8, v8, v38
    v_fmac_f32 v9, v38, v38
    v_add_f32 v10, v10, v46
    v_fmac_f32 v11, v46, v46
    v_add_f32 v8, v8, v39
    v_fmac_f32 v9, v39, v39
    v_add_f32 v10, v10, v47
    v_fmac_f32 v11, v47, v47
    v_add_f32_dpp v8, v8, v8 row_ror:8 row_mask:0xf bank_mask:0xf
    v_add_f32_dpp v9, v9, v9 row_ror:8 row_mask:0xf bank_mask:0xf
    v_add_f32_dpp v10, v10, v10 row_ror:8 row_mask:0xf bank_mask:0xf
    v_add_f32_dpp v11, v11, v11 row_ror:8 row_mask:0xf bank_mask:0xf
    v_add_f32_dpp v8, v8, v8 row_ror:4 row_mask:0xf bank_mask:0xf
    v_add_f32_dpp v9, v9, v9 row_ror:4 row_mask:0xf bank_mask:0xf
    v_add_f32_dpp v10, v10, v10 row_ror:4 row_mask:0xf bank_mask:0xf
    v_add_f32_dpp v11, v11, v11 row_ror:4 row_mask:0xf bank_mask:0xf
    v_add_f32_dpp v8, v8, v8 row_ror:2 row_mask:0xf bank_mask:0xf
    v_add_f32_dpp v9, v9, v9 row_ror:2 row_mask:0xf bank_mask:0xf
    v_add_f32_dpp v10, v10, v10 row_ror:2 row_mask:0xf bank_mask:0xf
    v_add_f32_dpp v11, v11, v11 row_ror:2 row_mask:0xf bank_mask:0xf
    v_add_f32_dpp v8, v8, v8 row_ror:1 row_mask:0xf bank_mask:0xf
    v_add_f32_dpp v9, v9, v9 row_ror:1 row_mask:0xf bank_mask:0xf
    v_add_f32_dpp v10, v10, v10 row_ror:1 row_mask:0xf bank_mask:0xf
    v_add_f32_dpp v11, v11, v11 row_ror:1 row_mask:0xf bank_mask:0xf
    v_add_f32_dpp v8, v8, v8 row_bcast:15 row_mask:0xa bank_mask:0xf
    v_add_f32_dpp v9, v9, v9 row_bcast:15 row_mask:0xa bank_mask:0xf
    v_add_f32_dpp v10, v10, v10 row_bcast:15 row_mask:0xa bank_mask:0xf
    v_add_f32_dpp v11, v11, v11 row_bcast:15 row_mask:0xa bank_mask:0xf
    v_add_f32_dpp v8, v8, v8 row_bcast:31 row_mask:0xc bank_mask:0xf
    v_add_f32_dpp v9, v9, v9 row_bcast:31 row_mask:0xc bank_mask:0xf
    v_add_f32_dpp v10, v10, v10 row_bcast:31 row_mask:0xc bank_mask:0xf
    v_add_f32_dpp v11, v11, v11 row_bcast:31 row_mask:0xc bank_mask:0xf
    v_mov_b32 v12, 0x3b000000
    v_mul_f32 v8, v8, v12
    v_mul_f32 v9, v9, v12
    v_mul_f32 v10, v10, v12
    v_mul_f32 v11, v11, v12
    v_fma_f32 v9, -v8, v8, v9
    v_add_f32 v8, s16, v8
    v_fma_f32 v11, -v10, v10, v11
    v_add_f32 v10, s17, v10
    v_max_f32 v9, 0, v9
    v_max_f32 v11, 0, v11
    v_cvt_pk_bf16_f32 v13, v8, v9
    v_lshlrev_b32 v8, 16, v13
    v_and_b32 v9, 0xffff0000, v13
    v_cvt_pk_bf16_f32 v14, v10, v11
    v_lshlrev_b32 v10, 16, v14
    v_and_b32 v11, 0xffff0000, v14
    v_add_f32 v9, 0x3727c5ac, v9
    v_add_f32 v11, 0x3727c5ac, v11
    v_cvt_pk_bf16_f32 v9, v9, v9
    v_and_b32 v9, 0xffff0000, v9
    v_cvt_pk_bf16_f32 v11, v11, v11
    v_and_b32 v11, 0xffff0000, v11
    v_sqrt_f32 v9, v9
    v_sqrt_f32 v11, v11
    v_cvt_pk_bf16_f32 v9, v9, v9
    v_and_b32 v9, 0xffff0000, v9
    v_cvt_pk_bf16_f32 v11, v11, v11
    v_and_b32 v11, 0xffff0000, v11
    v_rcp_f32 v9, v9
    v_rcp_f32 v11, v11
    s_mov_b32 s16, 0
    s_brev_b32 s17, 1
    s_and_b64 exec, s[98:99], s[16:17]
    ds_write_b128 v28, v[8:11] offset:21504
    s_mov_b64 exec, s[98:99]
    s_waitcnt lgkmcnt(0)
    s_cbranch_execz Lb_34
    s_barrier
Lb_34:
    s_cbranch_execz L_dryret
    s_branch L_fin
L_segH:
    s_lshr_b32 s26, s97, 4
    s_and_b32 s27, s97, 15
    v_lshrrev_b32 v18, 3, v0
    v_and_b32 v19, 7, v0
    v_lshlrev_b32 v19, 4, v19
    v_lshl_add_u32 v16, v18, 11, v19
    v_lshl_add_u32 v17, v18, 12, v19
    s_lshl_b32 s24, s3, 7
    v_add_u32 v19, s24, v19
    v_and_b32 v23, 31, v0
    v_lshlrev_b32 v25, 2, v23
    v_lshrrev_b32 v24, 5, v0
    v_lshl_add_u32 v24, v24, 10, v25
    v_and_b32 v20, 3, v23
    v_lshlrev_b32 v20, 4, v20
    v_lshrrev_b32 v23, 2, v23
    v_lshl_add_u32 v20, v23, 1, v20
    s_lshl_b32 s28, s27, 6
    buffer_load_ushort v22, v20, s[84:87], s28 offen
    s_lshl_b32 s24, s26, 10
    s_add_u32 s28, s28, s24
    buffer_load_ushort v21, v20, s[60:63], s28 offen
    s_lshl_b32 s24, s26, 18
    s_lshl_b32 s25, s3, 14
    s_add_u32 s24, s24, s25
    s_lshl_b32 s25, s27, 7
    s_add_u32 s24, s24, s25
    s_add_u32 s24, s24, 0x10000
    v_cmp_gt_u32 vcc, 86, v52
    s_mov_b32 s25, 0
    s_and_b64 s[16:17], s[98:99], vcc
    s_mov_b32 s29, 0
    s_nop 1
    s_branch Lptchk_37
Lpt_35:
    s_mov_b64 exec, s[16:17]
    buffer_load_dwordx4 v[56:59], v53, s[64:67], s25 offen sc1
    s_mov_b64 exec, s[98:99]
    s_cbranch_execz Lw_38
    s_waitcnt vmcnt(0)
Lw_38:
Lptchk_37:
    s_mov_b64 exec, s[16:17]
    v_cmp_ne_u64 s[16:17], s[40:41], v[58:59]
    s_or_b64 s[100:101], s[16:17], s[16:17]
    s_cbranch_scc0 Lptdone_36
    s_add_u32 s29, s29, 1
    s_cmp_lt_u32 s29, 200000
    s_cbranch_scc0 Lptdone_36
    s_sleep 2
    s_branch Lpt_35
Lptdone_36:
    s_mov_b64 exec, s[98:99]
    s_mov_b64 s[16:17], s[98:99]
    s_mov_b32 s29, 0
    s_branch Lptchk_41
Lpt_39:
    s_mov_b64 exec, s[16:17]
    buffer_load_dwordx4 v[60:63], v54, s[64:67], s25 offen sc1
    s_mov_b64 exec, s[98:99]
    s_cbranch_execz Lw_42
    s_waitcnt vmcnt(0)
Lw_42:
Lptchk_41:
    s_mov_b64 exec, s[16:17]
    v_cmp_ne_u64 s[16:17], s[40:41], v[62:63]
    s_or_b64 s[100:101], s[16:17], s[16:17]
    s_cbranch_scc0 Lptdone_40
    s_add_u32 s29, s29, 1
    s_cmp_lt_u32 s29, 200000
    s_cbranch_scc0 Lptdone_40
    s_sleep 2
    s_branch Lpt_39
Lptdone_40:
    s_mov_b64 exec, s[98:99]
    v_mov_b32 v44, v60
    v_mov_b32 v45, v61
    v_mov_b32 v46, v44
    s_nop 1
    v_max_f32_dpp v46, v46, v46 row_ror:8 row_mask:0xf bank_mask:0xf
    v_mov_b32 v47, v46
    s_nop 1
    v_permlane16_swap_b32 v46, v47
    v_max_f32 v46, v46, v47
    v_sub_f32 v44, v44, v46
    v_exp_f32 v44, v44
    s_nop 0
    v_mul_f32 v45, v45, v44
    s_nop 1
    v_add_f32_dpp v45, v45, v45 row_ror:8 row_mask:0xf bank_mask:0xf
    v_mov_b32 v47, v45
    s_nop 1
    v_permlane16_swap_b32 v45, v47
    v_add_f32 v45, v45, v47
    v_rcp_f32 v45, v45
    s_nop 0
    v_mul_f32 v44, v44, v45
    s_mov_b64 s[16:17], s[98:99]
    s_mov_b32 s29, 0
Lpoll_43:
    s_mov_b64 exec, s[16:17]
    buffer_load_dwordx4 v[32:35], v16, s[64:67], s24 offen sc1
    s_mov_b64 exec, s[98:99]
    s_cbranch_execz Lw_45
    s_waitcnt vmcnt(0)
Lw_45:
    s_mov_b64 exec, s[16:17]
    v_max3_u32 v31, v32, v33, v34
    v_max_u32 v31, v31, v35
    v_cmp_eq_u32 s[16:17], -1, v31
    s_or_b64 s[100:101], s[16:17], s[16:17]
    s_cbranch_scc0 Lpolldone_44
    s_add_u32 s29, s29, 1
    s_cmp_lt_u32 s29, 200000
    s_cbranch_scc0 Lpolldone_44
    s_sleep 1
    s_branch Lpoll_43
Lpolldone_44:
    s_mov_b64 exec, s[98:99]
    v_mul_f32 v32, v32, v44
    v_mul_f32 v33, v33, v44
    v_mul_f32 v34, v34, v44
    v_mul_f32 v35, v35, v44
    v_add_f32_dpp v32, v32, v32 row_ror:8 row_mask:0xf bank_mask:0xf
    v_add_f32_dpp v33, v33, v33 row_ror:8 row_mask:0xf bank_mask:0xf
    v_add_f32_dpp v34, v34, v34 row_ror:8 row_mask:0xf bank_mask:0xf
    v_add_f32_dpp v35, v35, v35 row_ror:8 row_mask:0xf bank_mask:0xf
    v_mov_b32 v36, v32
    v_mov_b32 v37, v33
    v_mov_b32 v38, v34
    v_mov_b32 v39, v35
    v_permlane16_swap_b32 v32, v36
    v_permlane16_swap_b32 v33, v37
    v_permlane16_swap_b32 v34, v38
    v_permlane16_swap_b32 v35, v39
    v_add_f32 v32, v32, v36
    v_add_f32 v33, v33, v37
    v_add_f32 v34, v34, v38
    v_add_f32 v35, v35, v39
    v_mov_b32 v36, v32
    v_mov_b32 v37, v33
    v_mov_b32 v38, v34
    v_mov_b32 v39, v35
    v_permlane32_swap_b32 v32, v36
    v_permlane32_swap_b32 v33, v37
    v_permlane32_swap_b32 v34, v38
    v_permlane32_swap_b32 v35, v39
    v_add_f32 v32, v32, v36
    v_add_f32 v33, v33, v37
    v_add_f32 v34, v34, v38
    v_add_f32 v35, v35, v39
    s_and_b64 exec, s[98:99], 0xff
    ds_write_b128 v19, v[32:35] offset:8192
    s_mov_b64 exec, s[98:99]
    v_mov_b32 v40, 0
    v_mov_b32 v41, 0
    v_mov_b32 v42, 0
    v_mov_b32 v43, 0
    s_lshl_b32 s24, s3, 15
    s_lshl_b32 s25, s97, 7
    s_add_u32 s24, s24, s25
    s_add_u32 s24, s24, 0x100000
    s_waitcnt lgkmcnt(0)
    s_cbranch_execz Lb_46
    s_barrier
Lb_46:
    s_cbranch_execz L_dryret
    s_cmp_gt_u32 s3, 10
    s_cbranch_scc1 L_fin
    s_cmp_lg_u32 s3, 0
    s_cbranch_scc1 L_segJ
L_segI:
    ds_read_b32 v32, v24 offset:8192
    ds_read_b32 v33, v24 offset:8320
    ds_read_b32 v34, v24 offset:8448
    ds_read_b32 v35, v24 offset:8576
    ds_read_b32 v36, v24 offset:8704
    ds_read_b32 v37, v24 offset:8832
    ds_read_b32 v38, v24 offset:8960
    ds_read_b32 v39, v24 offset:9088
    v_lshlrev_b32 v21, 16, v21
    v_lshlrev_b32 v22, 16, v22
    s_lshl_b32 s25, s97, 7
    s_add_u32 s25, s25, 0x8000
    s_waitcnt lgkmcnt(6)
    v_add_f32 v32, v32, v33
    s_waitcnt lgkmcnt(4)
    v_add_f32 v34, v34, v35
    s_waitcnt lgkmcnt(2)
    v_add_f32 v36, v36, v37
    s_waitcnt lgkmcnt(0)
    v_add_f32 v38, v38, v39
    v_add_f32 v32, v32, v34
    v_add_f32 v36, v36, v38
    v_add_f32 v32, v32, v36
    v_mov_b32 v33, v32
    s_nop 1
    v_permlane32_swap_b32 v32, v33
    v_add_f32 v32, v32, v33
    v_cvt_pk_bf16_f32 v32, v32, v32
    v_and_b32 v32, 0xffff0000, v32
    v_add_f32 v26, v32, v21
    v_cvt_pk_bf16_f32 v26, v26, v26
    v_and_b32 v26, 0xffff0000, v26
    s_and_b64 exec, s[98:99], 0xffffffff
    buffer_store_dword v26, v25, s[64:67], s25 offen sc1
    s_mov_b64 exec, s[98:99]
    s_cbranch_execz L_dryret
L_segJ:
    s_lshl_b32 s25, s3, 3
    v_add_u32 v27, s25, v18
    v_cmp_gt_u32 vcc, 86, v27
    s_and_b64 s[16:17], s[98:99], vcc
    s_mov_b32 s29, 0
    s_nop 2
Lpoll_47:
    s_mov_b64 exec, s[16:17]
    buffer_load_dwordx4 v[40:43], v17, s[64:67], s24 offen sc1
    s_mov_b64 exec, s[98:99]
    s_cbranch_execz Lw_49
    s_waitcnt vmcnt(0)
Lw_49:
    s_mov_b64 exec, s[16:17]
    v_max3_u32 v31, v40, v41, v42
    v_max_u32 v31, v31, v43
    v_cmp_eq_u32 s[16:17], -1, v31
    s_or_b64 s[100:101], s[16:17], s[16:17]
    s_cbranch_scc0 Lpolldone_48
    s_add_u32 s29, s29, 1
    s_cmp_lt_u32 s29, 200000
    s_cbranch_scc0 Lpolldone_48
    s_sleep 1
    s_branch Lpoll_47
Lpolldone_48:
    s_mov_b64 exec, s[98:99]
    v_add_f32_dpp v40, v40, v40 row_ror:8 row_mask:0xf bank_mask:0xf
    v_add_f32_dpp v41, v41, v41 row_ror:8 row_mask:0xf bank_mask:0xf
    v_add_f32_dpp v42, v42, v42 row_ror:8 row_mask:0xf bank_mask:0xf
    v_add_f32_dpp v43, v43, v43 row_ror:8 row_mask:0xf bank_mask:0xf
    v_mov_b32 v36, v40
    v_mov_b32 v37, v41
    v_mov_b32 v38, v42
    v_mov_b32 v39, v43
    v_permlane16_swap_b32 v40, v36
    v_permlane16_swap_b32 v41, v37
    v_permlane16_swap_b32 v42, v38
    v_permlane16_swap_b32 v43, v39
    v_add_f32 v40, v40, v36
    v_add_f32 v41, v41, v37
    v_add_f32 v42, v42, v38
    v_add_f32 v43, v43, v39
    v_mov_b32 v36, v40
    v_mov_b32 v37, v41
    v_mov_b32 v38, v42
    v_mov_b32 v39, v43
    v_permlane32_swap_b32 v40, v36
    v_permlane32_swap_b32 v41, v37
    v_permlane32_swap_b32 v42, v38
    v_permlane32_swap_b32 v43, v39
    v_add_f32 v40, v40, v36
    v_add_f32 v41, v41, v37
    v_add_f32 v42, v42, v38
    v_add_f32 v43, v43, v39
    s_and_b64 exec, s[98:99], 0xff
    ds_write_b128 v19, v[40:43] offset:10240
    s_mov_b64 exec, s[98:99]
    s_waitcnt lgkmcnt(0)
    s_cbranch_execz Lb_50
    s_barrier
Lb_50:
    s_cbranch_execz L_j2
    s_cmp_lg_u32 s3, 0
    s_cbranch_scc1 L_fin
L_j2:
    v_lshrrev_b32 v27, 5, v0
    v_mul_u32_u24 v27, 768, v27
    v_add_u32 v27, v27, v25
    ds_read_b32 v32, v27 offset:10240
    ds_read_b32 v33, v27 offset:10368
    ds_read_b32 v34, v27 offset:10496
    ds_read_b32 v35, v27 offset:10624
    ds_read_b32 v36, v27 offset:10752
    ds_read_b32 v37, v27 offset:10880
    s_mov_b32 s16, -1
    s_mov_b32 s17, 0
    s_waitcnt lgkmcnt(0)
    v_cndmask_b32 v37, 0, v37, s[16:17]
    v_add_f32 v32, v32, v33
    v_add_f32 v34, v34, v35
    v_add_f32 v36, v36, v37
    v_add_f32 v32, v32, v34
    v_add_f32 v32, v32, v36
    v_mov_b32 v33, v32
    s_nop 1
    v_permlane32_swap_b32 v32, v33
    v_add_f32 v32, v32, v33
    v_cvt_pk_bf16_f32 v32, v32, v32
    v_and_b32 v32, 0xffff0000, v32
    v_add_f32 v32, v32, v22
    v_cvt_pk_bf16_f32 v32, v32, v32
    v_and_b32 v32, 0xffff0000, v32
    v_add_f32 v32, v32, v26
    v_cvt_pk_bf16_f32 v32, v32, v32
    s_and_b64 exec, s[98:99], 0xffffffff
    buffer_store_short v32, v20, s[88:91], s28 offen
    s_mov_b64 exec, s[98:99]
    s_cbranch_execz L_dryret
L_fin:
L_end:
    s_endpgm
.section .rodata,"a"
.p2align 6
.amdhsa_kernel sequential_preLN__mha_block_cached__dense_activation_gelu__decode_kernel
  .amdhsa_next_free_vgpr 128
  .amdhsa_next_free_sgpr 102
  .amdhsa_accum_offset 128
  .amdhsa_group_segment_fixed_size 0
  .amdhsa_kernarg_size 104
  .amdhsa_user_sgpr_count 2
  .amdhsa_user_sgpr_kernarg_segment_ptr 1
  .amdhsa_system_sgpr_workgroup_id_x 1
  .amdhsa_float_denorm_mode_32 3
.end_amdhsa_kernel
```
